```python
import torch

def _softmax(x, axis=-1):
    return torch.softmax(x, dim=axis)
def _gelu(x):
    return torch.nn.functional.gelu(x, approximate="tanh")
def _silu(x):
    return torch.nn.functional.silu(x)
def _sigmoid(x):
    return torch.sigmoid(x)
def _layernorm(x, axis=-1, eps=1e-5):
    m = x.mean(dim=axis, keepdim=True)
    v = x.var(dim=axis, keepdim=True, unbiased=False)
    return (x - m) / torch.sqrt(v + eps)
def _scatter_add(tgt, idx, src, axis=0):
    return tgt.clone().index_add_(axis, idx, src)
def _segment_sum(src, seg, n):
    out = torch.zeros((n,) + src.shape[1:], dtype=src.dtype)
    return out.index_add_(0, seg, src)
def _pad(x, pw):
    flat = tuple(v for pair in reversed(pw) for v in pair)
    return torch.nn.functional.pad(x, flat)

kernel_name = 'standalone__self_sup_conv_stem_wavlm__speech'

def setup_inputs():

    _w = (lambda a: (lambda t: t.to(torch.bfloat16) if t.is_floating_point() else t)(torch.as_tensor(a)))
    B, T, D, K = 2, 16000, 512, 3
    scale = (K * D) ** -0.5
    return {
        "x": _w((lambda *s: torch.randn(*s, dtype=torch.bfloat16) * 0.05)(B, T, D)),
        "w": _w((lambda *s: torch.randn(*s, dtype=torch.bfloat16) * 0.05)(K, D, D) * scale),
        "gn_gamma": _w((lambda *s: torch.randn(*s, dtype=torch.bfloat16) * 0.05)(D) * 0.1 + 1.0),
        "gn_beta": _w((lambda *s: torch.randn(*s, dtype=torch.bfloat16) * 0.05)(D) * 0.1),
    }

def reference(x, w, gn_gamma, gn_beta):
    B, T, D = x.shape
    K = w.shape[0]
    s = 2
    L = (T - K) // s + 1
    h = torch.einsum('blc,cd->bld', x[:, 0:s * L:s, :], w[0])
    for i in range(1, K):
        h = h + torch.einsum('blc,cd->bld', x[:, i:i + s * L:s, :], w[i])
    mu = torch.einsum('bld->bd', h)[:, None, :] / L
    var = torch.einsum('bld->bd', (h - mu) ** 2)[:, None, :] / L
    h = (h - mu) / torch.sqrt(var + 1e-5)
    h = h * gn_gamma[None, None, :] + gn_beta[None, None, :]
    return _gelu(h)
```

```asm
; @launch grid=(256,1,1) block=(512,1,1) lds=163840
.amdgcn_target "amdgcn-amd-amdhsa--gfx950"
.text
.globl standalone__self_sup_conv_stem_wavlm__speech_kernel
.p2align 12
.p2align 8
.type standalone__self_sup_conv_stem_wavlm__speech_kernel,@function
standalone__self_sup_conv_stem_wavlm__speech_kernel:
    s_cmp_ge_u32 s2, 256
    s_cbranch_scc1 L_end
    s_load_dwordx4 s[4:7], s[0:1], 0
    s_load_dwordx4 s[8:11], s[0:1], 16
    s_load_dwordx4 s[12:15], s[0:1], 32
    s_load_dwordx2 s[16:17], s[0:1], 48
    v_lshrrev_b32 v1, 6, v0
    v_and_b32 v0, 63, v0
    s_lshr_b32 s52, s2, 3
    v_readfirstlane_b32 s51, v1
    s_lshr_b32 s48, s52, 3
    s_xor_b32 s48, s48, 1
    s_and_b32 s52, s52, 7
    s_and_b32 s53, s2, 7
    s_lshl_b32 s53, s53, 3
    s_add_u32 s52, s52, s53
    s_lshr_b32 s50, s52, 5
    s_and_b32 s49, s52, 31
    s_lshl_b32 s63, s50, 2
    s_add_u32 s63, s63, s48
    s_mov_b32 s55, 65536
    s_mov_b32 s56, 0
    s_mov_b32 s58, 0
    s_mov_b32 s57, 0
    s_cmp_lt_u32 s51, 4
    s_cbranch_scc1 L_compute
    s_sub_u32 s54, s51, 4
    v_lshrrev_b32 v1, 3, v0
    v_lshrrev_b32 v2, 4, v0
    v_and_b32 v3, 7, v0
    v_xor_b32 v3, v3, v2
    v_lshlrev_b32 v3, 4, v3
    v_lshl_add_u32 v3, v1, 14, v3
    s_lshr_b32 s52, s54, 1
    s_mul_i32 s29, s52, 1015808
    s_lshl_b32 s52, s52, 18
    s_and_b32 s53, s54, 1
    s_lshl_b32 s53, s53, 13
    s_add_u32 s52, s52, s53
    v_add_u32 v8, s52, v3
    v_xor_b32 v4, 64, v8
    v_add_u32 v9, 130048, v4
    v_add_u32 v10, 0, v8
    v_add_u32 v11, 130048, v4
    v_add_u32 v12, 4096, v8
    v_add_u32 v13, 134144, v4
    v_add_u32 v14, 4096, v8
    v_add_u32 v15, 134144, v4
    v_lshlrev_b32 v5, 2, v2
    v_and_b32 v6, 15, v0
    v_xor_b32 v5, v5, v6
    v_lshlrev_b32 v5, 4, v5
    v_lshl_add_u32 v5, v2, 10, v5
    s_lshl_b32 s52, s54, 14
    v_add_u32 v16, s52, v5
    v_add_u32 v17, 3072, v16
    v_add_u32 v18, 6144, v16
    v_add_u32 v19, 9216, v16
    s_lshl_b32 s59, s54, 13
    s_lshl_b32 s60, s54, 12
    s_mul_i32 s52, s50, 16384000
    s_mul_i32 s53, s49, 512000
    s_add_u32 s52, s52, s53
    s_cmp_eq_u32 s49, 31
    s_cselect_b32 s22, 0, 1024
    s_add_u32 s22, s22, 512000
    s_mov_b32 s23, 0x00020000
    s_lshl_b32 s53, s48, 8
    s_sub_u32 s26, 1572864, s53
    s_mov_b32 s27, 0x00020000
    s_waitcnt lgkmcnt(0)
    s_add_u32 s20, s4, s52
    s_addc_u32 s21, s5, 0
    s_add_u32 s24, s6, s53
    s_addc_u32 s25, s7, 0
    s_lshl_b32 s76, s48, 2
    s_add_u32 s76, s76, s54
    s_lshl_b32 s76, s76, 15
    s_add_u32 s77, s76, 32768
    s_mov_b32 s75, s76
    s_mov_b32 s76, 0x7f000000
L_ld_loop:
    s_xor_b32 s79, s58, 4
    s_cmp_eq_u32 s58, 3
    s_cselect_b32 s76, s75, s76
    s_lshl_b32 s62, s79, 16
    s_add_u32 s62, s62, s29
    s_add_u32 m0, s56, s60
    s_add_u32 s56, s56, 16384
    buffer_load_dwordx4 v16, s[24:27], s62 offen offset:0  lds
    buffer_load_dwordx4 v17, s[24:27], s62 offen offset:1024  lds
    buffer_load_dwordx4 v18, s[24:27], s62 offen offset:2048  lds
    buffer_load_dwordx4 v19, s[24:27], s62 offen offset:3072  lds
    s_and_b32 s56, s56, 65535
    s_lshl_b32 s61, s79, 7
    s_add_u32 m0, s55, s59
    s_add_u32 s55, s55, 32768
    buffer_load_dwordx4 v8, s[20:23], s61 offen offset:0  lds
    buffer_load_dwordx4 v9, s[20:23], s61 offen offset:1024  lds
    buffer_load_dwordx4 v10, s[20:23], s61 offen offset:2048  lds
    buffer_load_dwordx4 v11, s[20:23], s61 offen offset:3072  lds
    s_add_u32 m0, m0, 4096
    s_cmp_eq_u32 s55, 163840
    buffer_load_dwordx4 v12, s[20:23], s61 offen offset:0  lds
    buffer_load_dwordx4 v13, s[20:23], s61 offen offset:1024  lds
    buffer_load_dwordx4 v14, s[20:23], s61 offen offset:2048  lds
    buffer_load_dwordx4 v15, s[20:23], s61 offen offset:3072  lds
    s_cselect_b32 s55, 65536, s55
    s_cmp_lt_u32 s76, s77
    s_cbranch_scc0 L_sp0
    s_buffer_load_dwordx2 s[64:65], s[20:23], s76 offset:444
    s_buffer_load_dwordx2 s[66:67], s[20:23], s76 offset:1468
    s_buffer_load_dwordx2 s[68:69], s[20:23], s76 offset:2492
L_sp0:
    s_add_u32 s76, s76, 3072
    s_cmp_lt_u32 s58, 2
    s_cbranch_scc1 L_ld_a
    s_waitcnt vmcnt(24)
    s_barrier
L_ld_a:
    s_lshl_b32 s62, s79, 16
    s_add_u32 s62, s62, s29
    s_add_u32 s62, s62, 32768
    s_add_u32 m0, s56, s60
    s_add_u32 s56, s56, 16384
    buffer_load_dwordx4 v16, s[24:27], s62 offen offset:0  lds
    buffer_load_dwordx4 v17, s[24:27], s62 offen offset:1024  lds
    buffer_load_dwordx4 v18, s[24:27], s62 offen offset:2048  lds
    buffer_load_dwordx4 v19, s[24:27], s62 offen offset:3072  lds
    s_and_b32 s56, s56, 65535
    s_cmp_lt_u32 s76, s77
    s_cbranch_scc0 L_sp1
    s_buffer_load_dwordx2 s[64:65], s[20:23], s76 offset:444
    s_buffer_load_dwordx2 s[66:67], s[20:23], s76 offset:1468
    s_buffer_load_dwordx2 s[68:69], s[20:23], s76 offset:2492
L_sp1:
    s_add_u32 s76, s76, 3072
    s_cmp_eq_u32 s58, 6
    s_cbranch_scc1 L_cpe
L_cpe_back:
    s_cmp_lg_u32 s58, 0
    s_cbranch_scc1 L_ld_b
    s_waitcnt vmcnt(4)
L_ld_b:
    s_cmp_lg_u32 s58, 7
    s_cbranch_scc1 L_ld_c
    s_waitcnt vmcnt(4)
L_ld_c:
    s_waitcnt vmcnt(16)
    s_barrier
    s_lshl_b32 s61, s79, 7
    s_add_u32 s61, s61, 1024
    s_add_u32 m0, s55, s59
    s_add_u32 s55, s55, 32768
    buffer_load_dwordx4 v8, s[20:23], s61 offen offset:0  lds
    buffer_load_dwordx4 v9, s[20:23], s61 offen offset:1024  lds
    buffer_load_dwordx4 v10, s[20:23], s61 offen offset:2048  lds
    buffer_load_dwordx4 v11, s[20:23], s61 offen offset:3072  lds
    s_add_u32 m0, m0, 4096
    s_cmp_eq_u32 s55, 163840
    buffer_load_dwordx4 v12, s[20:23], s61 offen offset:0  lds
    buffer_load_dwordx4 v13, s[20:23], s61 offen offset:1024  lds
    buffer_load_dwordx4 v14, s[20:23], s61 offen offset:2048  lds
    buffer_load_dwordx4 v15, s[20:23], s61 offen offset:3072  lds
    s_cselect_b32 s55, 65536, s55
    s_lshl_b32 s62, s79, 16
    s_add_u32 s62, s62, 524288
    s_add_u32 m0, s56, s60
    s_add_u32 s56, s56, 16384
    buffer_load_dwordx4 v16, s[24:27], s62 offen offset:0  lds
    buffer_load_dwordx4 v17, s[24:27], s62 offen offset:1024  lds
    buffer_load_dwordx4 v18, s[24:27], s62 offen offset:2048  lds
    buffer_load_dwordx4 v19, s[24:27], s62 offen offset:3072  lds
    s_and_b32 s56, s56, 65535
    s_cmp_lt_u32 s76, s77
    s_cbranch_scc0 L_sp2
    s_buffer_load_dwordx2 s[64:65], s[20:23], s76 offset:444
    s_buffer_load_dwordx2 s[66:67], s[20:23], s76 offset:1468
    s_buffer_load_dwordx2 s[68:69], s[20:23], s76 offset:2492
L_sp2:
    s_add_u32 s76, s76, 3072
    s_add_u32 s58, s58, 1
    s_cmp_eq_u32 s58, 8
    s_cbranch_scc1 L_ld_out
    s_cmp_lg_u32 s58, 1
    s_cbranch_scc1 L_ld_d
    s_waitcnt vmcnt(12)
L_ld_d:
    s_waitcnt vmcnt(16)
    s_barrier
    s_branch L_ld_loop
L_count:
    s_waitcnt vmcnt(0)
    s_mov_b64 exec, 1
    buffer_atomic_add v21, v22, s[36:39], s61 offen
    s_mov_b64 exec, -1
    s_branch L_count_back
L_compute:
    s_setprio 1
    v_mov_b64 v[32:33], 0
    v_mov_b64 v[34:35], 0
    s_lshr_b32 s59, s51, 1
    s_and_b32 s60, s51, 1
    v_mfma_f32_32x32x16_bf16 v[128:143], v[32:35], v[32:35], 0
    v_add_u32 v6, 12, v0
    v_and_b32 v7, 7, v6
    v_bfe_u32 v6, v6, 3, 1
    v_mfma_f32_32x32x16_bf16 v[144:159], v[32:35], v[32:35], 0
    v_lshl_add_u32 v1, v7, 1, v6
    s_lshl_b32 s52, s59, 7
    v_lshrrev_b32 v6, 4, v0
    v_mfma_f32_32x32x16_bf16 v[160:175], v[32:35], v[32:35], 0
    v_add3_u32 v7, s52, v1, 0
    v_bfe_u32 v15, v7, 1, 3
    v_xor_b32 v15, v15, v6
    v_mfma_f32_32x32x16_bf16 v[176:191], v[32:35], v[32:35], 0
    v_lshlrev_b32 v15, 4, v15
    v_lshl_add_u32 v2, v7, 7, v15
    v_add3_u32 v7, s52, v1, 1
    v_mfma_f32_32x32x16_bf16 v[192:207], v[32:35], v[32:35], 0
    v_bfe_u32 v15, v7, 1, 3
    v_xor_b32 v15, v15, v6
    v_lshlrev_b32 v15, 4, v15
    v_mfma_f32_32x32x16_bf16 v[208:223], v[32:35], v[32:35], 0
    v_lshl_add_u32 v3, v7, 7, v15
    v_add_u32 v7, 1, v1
    v_lshrrev_b32 v7, 4, v7
    v_mfma_f32_32x32x16_bf16 v[224:239], v[32:35], v[32:35], 0
    v_mul_u32_u24 v7, 14336, v7
    v_add_u32 v3, v3, v7
    v_bfe_u32 v7, v0, 2, 2
    v_mfma_f32_32x32x16_bf16 v[240:255], v[32:35], v[32:35], 0
    v_lshl_add_u32 v15, v6, 3, v7
    v_lshlrev_b32 v15, 8, v15
    s_lshl_b32 s52, s60, 1
    v_xor_b32 v7, s52, v7
    v_lshl_add_u32 v15, v7, 6, v15
    v_and_b32 v7, 3, v0
    v_lshl_add_u32 v4, v7, 4, v15
    s_lshl_b32 s52, s63, 16
    s_mov_b32 s34, 65536
    s_mov_b32 s35, 0x00020000
    s_mov_b32 s38, 256
    s_mov_b32 s39, 0x00020000
    s_mov_b32 s62, 32768
    s_and_b32 s75, s49, 1
    s_add_u32 s75, s75, 1
    s_cmp_eq_u32 s51, 3
    s_cselect_b32 s75, s75, 63
    s_lshl_b32 s61, s63, 5
    s_lshl_b32 s53, s49, 10
    v_lshl_add_u32 v20, v0, 4, s53
    v_mov_b64 v[16:17], -1
    v_mov_b64 v[18:19], -1
    v_mov_b32 v21, 1
    v_mov_b32 v22, 0
    v_add_u32 v8, s55, v2
    v_xor_b32 v9, 64, v8
    v_add_u32 v11, s55, v3
    v_xor_b32 v13, 64, v11
    v_add_u32 v10, s56, v4
    v_xor_b32 v12, 64, v10
    s_waitcnt lgkmcnt(0)
    s_add_u32 s32, s16, s52
    s_addc_u32 s33, s17, 0
    s_mov_b32 s36, s14
    s_mov_b32 s37, s15
    s_barrier
    ds_read_b128 v[32:35], v8 offset:0
    ds_read_b128 v[36:39], v8 offset:2048
    ds_read_b64_tr_b16 v[64:65], v10 offset:0
    ds_read_b64_tr_b16 v[66:67], v10 offset:1024
    ds_read_b64_tr_b16 v[68:69], v10 offset:8192
    ds_read_b64_tr_b16 v[70:71], v10 offset:9216
    ds_read_b64_tr_b16 v[72:73], v10 offset:8
    ds_read_b64_tr_b16 v[74:75], v10 offset:1032
    ds_read_b64_tr_b16 v[76:77], v10 offset:8200
    ds_read_b64_tr_b16 v[78:79], v10 offset:9224
    ds_read_b64_tr_b16 v[80:81], v12 offset:0
    ds_read_b64_tr_b16 v[82:83], v12 offset:1024
    ds_read_b64_tr_b16 v[84:85], v12 offset:8192
    ds_read_b64_tr_b16 v[86:87], v12 offset:9216
    ds_read_b64_tr_b16 v[88:89], v12 offset:8
    ds_read_b64_tr_b16 v[90:91], v12 offset:1032
    ds_read_b64_tr_b16 v[92:93], v12 offset:8200
    ds_read_b64_tr_b16 v[94:95], v12 offset:9224
    ds_read_b128 v[40:43], v8 offset:4096
    ds_read_b128 v[44:47], v8 offset:6144
    ds_read_b128 v[48:51], v8 offset:8192
    ds_read_b128 v[52:55], v8 offset:10240
    s_cmp_lg_u32 s51, 3
    s_cbranch_scc1 L_c_loop
    buffer_store_dwordx4 v[16:19], v20, s[32:35], 0 offen offset:0 sc1
    buffer_store_dwordx4 v[16:19], v20, s[32:35], s62 offen offset:0 sc1
.p2align 6
L_c_loop:
    s_waitcnt lgkmcnt(4)
    v_mfma_f32_16x16x32_bf16 v[128:131], v[64:67], v[32:35], v[128:131]
    ds_read_b128 v[56:59], v8 offset:12288
    v_mfma_f32_16x16x32_bf16 v[128:131], v[68:71], v[36:39], v[128:131]
    ds_read_b128 v[60:63], v8 offset:14336
    v_mfma_f32_16x16x32_bf16 v[132:135], v[72:75], v[32:35], v[132:135]
    v_mfma_f32_16x16x32_bf16 v[132:135], v[76:79], v[36:39], v[132:135]
    s_add_u32 s56, s56, 16384
    v_mfma_f32_16x16x32_bf16 v[136:139], v[80:83], v[32:35], v[136:139]
    s_and_b32 s56, s56, 65535
    v_mfma_f32_16x16x32_bf16 v[136:139], v[84:87], v[36:39], v[136:139]
    v_add_u32 v10, s56, v4
    v_mfma_f32_16x16x32_bf16 v[140:143], v[88:91], v[32:35], v[140:143]
    v_xor_b32 v12, 64, v10
    v_mfma_f32_16x16x32_bf16 v[140:143], v[92:95], v[36:39], v[140:143]
    s_waitcnt lgkmcnt(5)
    v_mfma_f32_16x16x32_bf16 v[156:159], v[88:91], v[36:39], v[156:159]
    v_mfma_f32_16x16x32_bf16 v[156:159], v[92:95], v[40:43], v[156:159]
    v_mfma_f32_16x16x32_bf16 v[152:155], v[80:83], v[36:39], v[152:155]
    v_mfma_f32_16x16x32_bf16 v[152:155], v[84:87], v[40:43], v[152:155]
    v_mfma_f32_16x16x32_bf16 v[148:151], v[72:75], v[36:39], v[148:151]
    v_mfma_f32_16x16x32_bf16 v[148:151], v[76:79], v[40:43], v[148:151]
    v_mfma_f32_16x16x32_bf16 v[144:147], v[64:67], v[36:39], v[144:147]
    v_mfma_f32_16x16x32_bf16 v[144:147], v[68:71], v[40:43], v[144:147]
    s_waitcnt lgkmcnt(4)
    v_mfma_f32_16x16x32_bf16 v[160:163], v[64:67], v[40:43], v[160:163]
    v_mfma_f32_16x16x32_bf16 v[160:163], v[68:71], v[44:47], v[160:163]
    v_mfma_f32_16x16x32_bf16 v[164:167], v[72:75], v[40:43], v[164:167]
    v_mfma_f32_16x16x32_bf16 v[164:167], v[76:79], v[44:47], v[164:167]
    v_mfma_f32_16x16x32_bf16 v[168:171], v[80:83], v[40:43], v[168:171]
    v_mfma_f32_16x16x32_bf16 v[168:171], v[84:87], v[44:47], v[168:171]
    v_mfma_f32_16x16x32_bf16 v[172:175], v[88:91], v[40:43], v[172:175]
    v_mfma_f32_16x16x32_bf16 v[172:175], v[92:95], v[44:47], v[172:175]
    s_waitcnt lgkmcnt(3)
    v_mfma_f32_16x16x32_bf16 v[188:191], v[88:91], v[44:47], v[188:191]
    v_mfma_f32_16x16x32_bf16 v[188:191], v[92:95], v[48:51], v[188:191]
    v_mfma_f32_16x16x32_bf16 v[184:187], v[80:83], v[44:47], v[184:187]
    v_mfma_f32_16x16x32_bf16 v[184:187], v[84:87], v[48:51], v[184:187]
    v_mfma_f32_16x16x32_bf16 v[180:183], v[72:75], v[44:47], v[180:183]
    v_mfma_f32_16x16x32_bf16 v[180:183], v[76:79], v[48:51], v[180:183]
    v_mfma_f32_16x16x32_bf16 v[176:179], v[64:67], v[44:47], v[176:179]
    v_mfma_f32_16x16x32_bf16 v[176:179], v[68:71], v[48:51], v[176:179]
    s_waitcnt lgkmcnt(2)
    v_mfma_f32_16x16x32_bf16 v[192:195], v[64:67], v[48:51], v[192:195]
    ds_read_b128 v[44:47], v11 offset:0
    v_mfma_f32_16x16x32_bf16 v[192:195], v[68:71], v[52:55], v[192:195]
    v_mfma_f32_16x16x32_bf16 v[196:199], v[72:75], v[48:51], v[196:199]
    v_mfma_f32_16x16x32_bf16 v[196:199], v[76:79], v[52:55], v[196:199]
    v_mfma_f32_16x16x32_bf16 v[200:203], v[80:83], v[48:51], v[200:203]
    v_mfma_f32_16x16x32_bf16 v[200:203], v[84:87], v[52:55], v[200:203]
    v_mfma_f32_16x16x32_bf16 v[204:207], v[88:91], v[48:51], v[204:207]
    v_mfma_f32_16x16x32_bf16 v[204:207], v[92:95], v[52:55], v[204:207]
    s_waitcnt lgkmcnt(0)
    v_mfma_f32_16x16x32_bf16 v[220:223], v[88:91], v[52:55], v[220:223]
    s_barrier
    v_mfma_f32_16x16x32_bf16 v[220:223], v[92:95], v[56:59], v[220:223]
    ds_read_b128 v[32:35], v9 offset:0
    v_mfma_f32_16x16x32_bf16 v[216:219], v[80:83], v[52:55], v[216:219]
    ds_read_b128 v[36:39], v9 offset:2048
    v_mfma_f32_16x16x32_bf16 v[216:219], v[84:87], v[56:59], v[216:219]
    ds_read_b64_tr_b16 v[96:97], v10 offset:0
    v_mfma_f32_16x16x32_bf16 v[212:215], v[72:75], v[52:55], v[212:215]
    ds_read_b64_tr_b16 v[98:99], v10 offset:1024
    v_mfma_f32_16x16x32_bf16 v[212:215], v[76:79], v[56:59], v[212:215]
    ds_read_b64_tr_b16 v[100:101], v10 offset:8192
    v_mfma_f32_16x16x32_bf16 v[208:211], v[64:67], v[52:55], v[208:211]
    ds_read_b64_tr_b16 v[102:103], v10 offset:9216
    v_mfma_f32_16x16x32_bf16 v[208:211], v[68:71], v[56:59], v[208:211]
    ds_read_b64_tr_b16 v[104:105], v10 offset:8
    v_mfma_f32_16x16x32_bf16 v[224:227], v[64:67], v[56:59], v[224:227]
    ds_read_b64_tr_b16 v[106:107], v10 offset:1032
    v_mfma_f32_16x16x32_bf16 v[224:227], v[68:71], v[60:63], v[224:227]
    ds_read_b64_tr_b16 v[108:109], v10 offset:8200
    v_mfma_f32_16x16x32_bf16 v[228:231], v[72:75], v[56:59], v[228:231]
    ds_read_b64_tr_b16 v[110:111], v10 offset:9224
    v_mfma_f32_16x16x32_bf16 v[228:231], v[76:79], v[60:63], v[228:231]
    ds_read_b64_tr_b16 v[112:113], v12 offset:0
    v_mfma_f32_16x16x32_bf16 v[232:235], v[80:83], v[56:59], v[232:235]
    ds_read_b64_tr_b16 v[114:115], v12 offset:1024
    v_mfma_f32_16x16x32_bf16 v[232:235], v[84:87], v[60:63], v[232:235]
    ds_read_b64_tr_b16 v[116:117], v12 offset:8192
    v_mfma_f32_16x16x32_bf16 v[236:239], v[88:91], v[56:59], v[236:239]
    ds_read_b64_tr_b16 v[118:119], v12 offset:9216
    v_mfma_f32_16x16x32_bf16 v[236:239], v[92:95], v[60:63], v[236:239]
    ds_read_b64_tr_b16 v[120:121], v12 offset:8
    v_mfma_f32_16x16x32_bf16 v[252:255], v[88:91], v[60:63], v[252:255]
    ds_read_b64_tr_b16 v[122:123], v12 offset:1032
    v_mfma_f32_16x16x32_bf16 v[252:255], v[92:95], v[44:47], v[252:255]
    ds_read_b64_tr_b16 v[124:125], v12 offset:8200
    v_mfma_f32_16x16x32_bf16 v[248:251], v[80:83], v[60:63], v[248:251]
    ds_read_b64_tr_b16 v[126:127], v12 offset:9224
    v_mfma_f32_16x16x32_bf16 v[248:251], v[84:87], v[44:47], v[248:251]
    ds_read_b128 v[40:43], v9 offset:4096
    v_mfma_f32_16x16x32_bf16 v[244:247], v[72:75], v[60:63], v[244:247]
    ds_read_b128 v[48:51], v9 offset:8192
    v_mfma_f32_16x16x32_bf16 v[244:247], v[76:79], v[44:47], v[244:247]
    ds_read_b128 v[52:55], v9 offset:10240
    v_mfma_f32_16x16x32_bf16 v[240:243], v[64:67], v[60:63], v[240:243]
    v_mfma_f32_16x16x32_bf16 v[240:243], v[68:71], v[44:47], v[240:243]
    s_waitcnt lgkmcnt(3)
    v_mfma_f32_16x16x32_bf16 v[128:131], v[96:99], v[32:35], v[128:131]
    ds_read_b128 v[44:47], v9 offset:6144
    v_mfma_f32_16x16x32_bf16 v[128:131], v[100:103], v[36:39], v[128:131]
    ds_read_b128 v[56:59], v9 offset:12288
    v_mfma_f32_16x16x32_bf16 v[132:135], v[104:107], v[32:35], v[132:135]
    ds_read_b128 v[60:63], v9 offset:14336
    v_mfma_f32_16x16x32_bf16 v[132:135], v[108:111], v[36:39], v[132:135]
    s_add_u32 s56, s56, 16384
    v_mfma_f32_16x16x32_bf16 v[136:139], v[112:115], v[32:35], v[136:139]
    s_and_b32 s56, s56, 65535
    v_mfma_f32_16x16x32_bf16 v[136:139], v[116:119], v[36:39], v[136:139]
    s_add_u32 s55, s55, 32768
    v_mfma_f32_16x16x32_bf16 v[140:143], v[120:123], v[32:35], v[140:143]
    s_cmp_eq_u32 s55, 163840
    v_mfma_f32_16x16x32_bf16 v[140:143], v[124:127], v[36:39], v[140:143]
    s_waitcnt lgkmcnt(5)
    v_mfma_f32_16x16x32_bf16 v[156:159], v[120:123], v[36:39], v[156:159]
    v_mfma_f32_16x16x32_bf16 v[156:159], v[124:127], v[40:43], v[156:159]
    v_mfma_f32_16x16x32_bf16 v[152:155], v[112:115], v[36:39], v[152:155]
    v_mfma_f32_16x16x32_bf16 v[152:155], v[116:119], v[40:43], v[152:155]
    s_cselect_b32 s55, 65536, s55
    v_mfma_f32_16x16x32_bf16 v[148:151], v[104:107], v[36:39], v[148:151]
    v_add_u32 v10, s56, v4
    v_mfma_f32_16x16x32_bf16 v[148:151], v[108:111], v[40:43], v[148:151]
    v_xor_b32 v12, 64, v10
    v_mfma_f32_16x16x32_bf16 v[144:147], v[96:99], v[36:39], v[144:147]
    v_mfma_f32_16x16x32_bf16 v[144:147], v[100:103], v[40:43], v[144:147]
    s_waitcnt lgkmcnt(2)
    v_mfma_f32_16x16x32_bf16 v[160:163], v[96:99], v[40:43], v[160:163]
    v_mfma_f32_16x16x32_bf16 v[160:163], v[100:103], v[44:47], v[160:163]
    v_mfma_f32_16x16x32_bf16 v[164:167], v[104:107], v[40:43], v[164:167]
    v_mfma_f32_16x16x32_bf16 v[164:167], v[108:111], v[44:47], v[164:167]
    v_mfma_f32_16x16x32_bf16 v[168:171], v[112:115], v[40:43], v[168:171]
    v_mfma_f32_16x16x32_bf16 v[168:171], v[116:119], v[44:47], v[168:171]
    v_mfma_f32_16x16x32_bf16 v[172:175], v[120:123], v[40:43], v[172:175]
    v_mfma_f32_16x16x32_bf16 v[172:175], v[124:127], v[44:47], v[172:175]
    v_mfma_f32_16x16x32_bf16 v[188:191], v[120:123], v[44:47], v[188:191]
    v_mfma_f32_16x16x32_bf16 v[188:191], v[124:127], v[48:51], v[188:191]
    v_mfma_f32_16x16x32_bf16 v[184:187], v[112:115], v[44:47], v[184:187]
    v_mfma_f32_16x16x32_bf16 v[184:187], v[116:119], v[48:51], v[184:187]
    v_mfma_f32_16x16x32_bf16 v[180:183], v[104:107], v[44:47], v[180:183]
    v_mfma_f32_16x16x32_bf16 v[180:183], v[108:111], v[48:51], v[180:183]
    v_mfma_f32_16x16x32_bf16 v[176:179], v[96:99], v[44:47], v[176:179]
    v_mfma_f32_16x16x32_bf16 v[176:179], v[100:103], v[48:51], v[176:179]
    v_mfma_f32_16x16x32_bf16 v[192:195], v[96:99], v[48:51], v[192:195]
    ds_read_b128 v[44:47], v13 offset:0
    v_mfma_f32_16x16x32_bf16 v[192:195], v[100:103], v[52:55], v[192:195]
    v_mfma_f32_16x16x32_bf16 v[196:199], v[104:107], v[48:51], v[196:199]
    v_add_u32 v8, s55, v2
    v_mfma_f32_16x16x32_bf16 v[196:199], v[108:111], v[52:55], v[196:199]
    v_xor_b32 v9, 64, v8
    v_mfma_f32_16x16x32_bf16 v[200:203], v[112:115], v[48:51], v[200:203]
    v_mfma_f32_16x16x32_bf16 v[200:203], v[116:119], v[52:55], v[200:203]
    v_mfma_f32_16x16x32_bf16 v[204:207], v[120:123], v[48:51], v[204:207]
    s_cmp_eq_u32 s57, 3
    v_mfma_f32_16x16x32_bf16 v[204:207], v[124:127], v[52:55], v[204:207]
    s_waitcnt lgkmcnt(0)
    v_mfma_f32_16x16x32_bf16 v[220:223], v[120:123], v[52:55], v[220:223]
    s_barrier
    v_mfma_f32_16x16x32_bf16 v[220:223], v[124:127], v[56:59], v[220:223]
    ds_read_b128 v[32:35], v8 offset:0
    v_mfma_f32_16x16x32_bf16 v[216:219], v[112:115], v[52:55], v[216:219]
    ds_read_b128 v[36:39], v9 offset:0
    v_mfma_f32_16x16x32_bf16 v[216:219], v[116:119], v[56:59], v[216:219]
    ds_read_b64_tr_b16 v[64:65], v10 offset:0
    v_mfma_f32_16x16x32_bf16 v[212:215], v[104:107], v[52:55], v[212:215]
    ds_read_b64_tr_b16 v[66:67], v10 offset:1024
    v_mfma_f32_16x16x32_bf16 v[212:215], v[108:111], v[56:59], v[212:215]
    ds_read_b64_tr_b16 v[68:69], v10 offset:8192
    v_mfma_f32_16x16x32_bf16 v[208:211], v[96:99], v[52:55], v[208:211]
    ds_read_b64_tr_b16 v[70:71], v10 offset:9216
    v_mfma_f32_16x16x32_bf16 v[208:211], v[100:103], v[56:59], v[208:211]
    ds_read_b64_tr_b16 v[72:73], v10 offset:8
    v_mfma_f32_16x16x32_bf16 v[224:227], v[96:99], v[56:59], v[224:227]
    ds_read_b64_tr_b16 v[74:75], v10 offset:1032
    v_mfma_f32_16x16x32_bf16 v[224:227], v[100:103], v[60:63], v[224:227]
    ds_read_b64_tr_b16 v[76:77], v10 offset:8200
    v_mfma_f32_16x16x32_bf16 v[228:231], v[104:107], v[56:59], v[228:231]
    ds_read_b64_tr_b16 v[78:79], v10 offset:9224
    v_mfma_f32_16x16x32_bf16 v[228:231], v[108:111], v[60:63], v[228:231]
    ds_read_b64_tr_b16 v[80:81], v12 offset:0
    v_mfma_f32_16x16x32_bf16 v[232:235], v[112:115], v[56:59], v[232:235]
    ds_read_b64_tr_b16 v[82:83], v12 offset:1024
    v_mfma_f32_16x16x32_bf16 v[232:235], v[116:119], v[60:63], v[232:235]
    ds_read_b64_tr_b16 v[84:85], v12 offset:8192
    v_mfma_f32_16x16x32_bf16 v[236:239], v[120:123], v[56:59], v[236:239]
    ds_read_b64_tr_b16 v[86:87], v12 offset:9216
    v_mfma_f32_16x16x32_bf16 v[236:239], v[124:127], v[60:63], v[236:239]
    ds_read_b64_tr_b16 v[88:89], v12 offset:8
    v_mfma_f32_16x16x32_bf16 v[252:255], v[120:123], v[60:63], v[252:255]
    ds_read_b64_tr_b16 v[90:91], v12 offset:1032
    v_mfma_f32_16x16x32_bf16 v[252:255], v[124:127], v[44:47], v[252:255]
    ds_read_b64_tr_b16 v[92:93], v12 offset:8200
    v_mfma_f32_16x16x32_bf16 v[248:251], v[112:115], v[60:63], v[248:251]
    ds_read_b64_tr_b16 v[94:95], v12 offset:9224
    v_mfma_f32_16x16x32_bf16 v[248:251], v[116:119], v[44:47], v[248:251]
    ds_read_b128 v[40:43], v8 offset:2048
    v_mfma_f32_16x16x32_bf16 v[244:247], v[104:107], v[60:63], v[244:247]
    ds_read_b128 v[48:51], v8 offset:4096
    v_mfma_f32_16x16x32_bf16 v[244:247], v[108:111], v[44:47], v[244:247]
    ds_read_b128 v[52:55], v9 offset:4096
    v_mfma_f32_16x16x32_bf16 v[240:243], v[96:99], v[60:63], v[240:243]
    v_mfma_f32_16x16x32_bf16 v[240:243], v[100:103], v[44:47], v[240:243]
    s_cbranch_scc1 L_tail
    s_waitcnt lgkmcnt(3)
    v_mfma_f32_16x16x32_bf16 v[128:131], v[64:67], v[32:35], v[128:131]
    ds_read_b128 v[44:47], v9 offset:2048
    v_mfma_f32_16x16x32_bf16 v[128:131], v[68:71], v[36:39], v[128:131]
    ds_read_b128 v[56:59], v8 offset:6144
    v_mfma_f32_16x16x32_bf16 v[132:135], v[72:75], v[32:35], v[132:135]
    ds_read_b128 v[60:63], v9 offset:6144
    v_mfma_f32_16x16x32_bf16 v[132:135], v[76:79], v[36:39], v[132:135]
    s_add_u32 s56, s56, 16384
    v_mfma_f32_16x16x32_bf16 v[136:139], v[80:83], v[32:35], v[136:139]
    s_and_b32 s56, s56, 65535
    v_mfma_f32_16x16x32_bf16 v[136:139], v[84:87], v[36:39], v[136:139]
    s_add_u32 s55, s55, 32768
    v_mfma_f32_16x16x32_bf16 v[140:143], v[88:91], v[32:35], v[140:143]
    s_cmp_eq_u32 s55, 163840
    v_mfma_f32_16x16x32_bf16 v[140:143], v[92:95], v[36:39], v[140:143]
    s_waitcnt lgkmcnt(2)
    v_mfma_f32_16x16x32_bf16 v[156:159], v[88:91], v[40:43], v[156:159]
    ds_read_b128 v[32:35], v8 offset:8192
    v_mfma_f32_16x16x32_bf16 v[156:159], v[92:95], v[44:47], v[156:159]
    ds_read_b128 v[36:39], v9 offset:8192
    v_mfma_f32_16x16x32_bf16 v[152:155], v[80:83], v[40:43], v[152:155]
    v_mfma_f32_16x16x32_bf16 v[152:155], v[84:87], v[44:47], v[152:155]
    s_cselect_b32 s55, 65536, s55
    v_mfma_f32_16x16x32_bf16 v[148:151], v[72:75], v[40:43], v[148:151]
    v_add_u32 v10, s56, v4
    v_mfma_f32_16x16x32_bf16 v[148:151], v[76:79], v[44:47], v[148:151]
    v_xor_b32 v12, 64, v10
    v_mfma_f32_16x16x32_bf16 v[144:147], v[64:67], v[40:43], v[144:147]
    v_mfma_f32_16x16x32_bf16 v[144:147], v[68:71], v[44:47], v[144:147]
    v_mfma_f32_16x16x32_bf16 v[160:163], v[64:67], v[48:51], v[160:163]
    ds_read_b128 v[40:43], v8 offset:10240
    v_mfma_f32_16x16x32_bf16 v[160:163], v[68:71], v[52:55], v[160:163]
    ds_read_b128 v[44:47], v9 offset:10240
    v_mfma_f32_16x16x32_bf16 v[164:167], v[72:75], v[48:51], v[164:167]
    v_mfma_f32_16x16x32_bf16 v[164:167], v[76:79], v[52:55], v[164:167]
    v_mfma_f32_16x16x32_bf16 v[168:171], v[80:83], v[48:51], v[168:171]
    v_mfma_f32_16x16x32_bf16 v[168:171], v[84:87], v[52:55], v[168:171]
    v_mfma_f32_16x16x32_bf16 v[172:175], v[88:91], v[48:51], v[172:175]
    v_mfma_f32_16x16x32_bf16 v[172:175], v[92:95], v[52:55], v[172:175]
    s_waitcnt lgkmcnt(4)
    v_mfma_f32_16x16x32_bf16 v[188:191], v[88:91], v[56:59], v[188:191]
    ds_read_b128 v[48:51], v8 offset:12288
    v_mfma_f32_16x16x32_bf16 v[188:191], v[92:95], v[60:63], v[188:191]
    ds_read_b128 v[52:55], v9 offset:12288
    v_mfma_f32_16x16x32_bf16 v[184:187], v[80:83], v[56:59], v[184:187]
    v_mfma_f32_16x16x32_bf16 v[184:187], v[84:87], v[60:63], v[184:187]
    v_mfma_f32_16x16x32_bf16 v[180:183], v[72:75], v[56:59], v[180:183]
    v_mfma_f32_16x16x32_bf16 v[180:183], v[76:79], v[60:63], v[180:183]
    v_mfma_f32_16x16x32_bf16 v[176:179], v[64:67], v[56:59], v[176:179]
    v_mfma_f32_16x16x32_bf16 v[176:179], v[68:71], v[60:63], v[176:179]
    s_waitcnt lgkmcnt(4)
    v_mfma_f32_16x16x32_bf16 v[192:195], v[64:67], v[32:35], v[192:195]
    ds_read_b128 v[56:59], v8 offset:14336
    v_mfma_f32_16x16x32_bf16 v[192:195], v[68:71], v[36:39], v[192:195]
    ds_read_b128 v[60:63], v9 offset:14336
    v_mfma_f32_16x16x32_bf16 v[196:199], v[72:75], v[32:35], v[196:199]
    v_add_u32 v8, s55, v2
    v_mfma_f32_16x16x32_bf16 v[196:199], v[76:79], v[36:39], v[196:199]
    v_xor_b32 v9, 64, v8
    v_mfma_f32_16x16x32_bf16 v[200:203], v[80:83], v[32:35], v[200:203]
    v_add_u32 v11, s55, v3
    v_mfma_f32_16x16x32_bf16 v[200:203], v[84:87], v[36:39], v[200:203]
    v_xor_b32 v13, 64, v11
    v_mfma_f32_16x16x32_bf16 v[204:207], v[88:91], v[32:35], v[204:207]
    v_mfma_f32_16x16x32_bf16 v[204:207], v[92:95], v[36:39], v[204:207]
    s_waitcnt lgkmcnt(0)
    v_mfma_f32_16x16x32_bf16 v[220:223], v[88:91], v[40:43], v[220:223]
    s_barrier
    v_mfma_f32_16x16x32_bf16 v[220:223], v[92:95], v[44:47], v[220:223]
    ds_read_b128 v[32:35], v8 offset:0
    v_mfma_f32_16x16x32_bf16 v[216:219], v[80:83], v[40:43], v[216:219]
    ds_read_b128 v[36:39], v8 offset:2048
    v_mfma_f32_16x16x32_bf16 v[216:219], v[84:87], v[44:47], v[216:219]
    ds_read_b64_tr_b16 v[96:97], v10 offset:0
    v_mfma_f32_16x16x32_bf16 v[212:215], v[72:75], v[40:43], v[212:215]
    ds_read_b64_tr_b16 v[98:99], v10 offset:1024
    v_mfma_f32_16x16x32_bf16 v[212:215], v[76:79], v[44:47], v[212:215]
    ds_read_b64_tr_b16 v[100:101], v10 offset:8192
    v_mfma_f32_16x16x32_bf16 v[208:211], v[64:67], v[40:43], v[208:211]
    ds_read_b64_tr_b16 v[102:103], v10 offset:9216
    v_mfma_f32_16x16x32_bf16 v[208:211], v[68:71], v[44:47], v[208:211]
    ds_read_b64_tr_b16 v[104:105], v10 offset:8
    v_mfma_f32_16x16x32_bf16 v[224:227], v[64:67], v[48:51], v[224:227]
    ds_read_b64_tr_b16 v[106:107], v10 offset:1032
    v_mfma_f32_16x16x32_bf16 v[224:227], v[68:71], v[52:55], v[224:227]
    ds_read_b64_tr_b16 v[108:109], v10 offset:8200
    v_mfma_f32_16x16x32_bf16 v[228:231], v[72:75], v[48:51], v[228:231]
    ds_read_b64_tr_b16 v[110:111], v10 offset:9224
    v_mfma_f32_16x16x32_bf16 v[228:231], v[76:79], v[52:55], v[228:231]
    ds_read_b64_tr_b16 v[112:113], v12 offset:0
    v_mfma_f32_16x16x32_bf16 v[232:235], v[80:83], v[48:51], v[232:235]
    ds_read_b64_tr_b16 v[114:115], v12 offset:1024
    v_mfma_f32_16x16x32_bf16 v[232:235], v[84:87], v[52:55], v[232:235]
    ds_read_b64_tr_b16 v[116:117], v12 offset:8192
    v_mfma_f32_16x16x32_bf16 v[236:239], v[88:91], v[48:51], v[236:239]
    ds_read_b64_tr_b16 v[118:119], v12 offset:9216
    v_mfma_f32_16x16x32_bf16 v[236:239], v[92:95], v[52:55], v[236:239]
    ds_read_b64_tr_b16 v[120:121], v12 offset:8
    v_mfma_f32_16x16x32_bf16 v[252:255], v[88:91], v[56:59], v[252:255]
    ds_read_b64_tr_b16 v[122:123], v12 offset:1032
    v_mfma_f32_16x16x32_bf16 v[252:255], v[92:95], v[60:63], v[252:255]
    ds_read_b64_tr_b16 v[124:125], v12 offset:8200
    v_mfma_f32_16x16x32_bf16 v[248:251], v[80:83], v[56:59], v[248:251]
    ds_read_b64_tr_b16 v[126:127], v12 offset:9224
    v_mfma_f32_16x16x32_bf16 v[248:251], v[84:87], v[60:63], v[248:251]
    ds_read_b128 v[40:43], v8 offset:4096
    v_mfma_f32_16x16x32_bf16 v[244:247], v[72:75], v[56:59], v[244:247]
    ds_read_b128 v[44:47], v8 offset:6144
    v_mfma_f32_16x16x32_bf16 v[244:247], v[76:79], v[60:63], v[244:247]
    ds_read_b128 v[48:51], v8 offset:8192
    v_mfma_f32_16x16x32_bf16 v[240:243], v[64:67], v[56:59], v[240:243]
    ds_read_b128 v[52:55], v8 offset:10240
    v_mfma_f32_16x16x32_bf16 v[240:243], v[68:71], v[60:63], v[240:243]
    s_waitcnt lgkmcnt(4)
    v_mfma_f32_16x16x32_bf16 v[128:131], v[96:99], v[32:35], v[128:131]
    ds_read_b128 v[56:59], v8 offset:12288
    v_mfma_f32_16x16x32_bf16 v[128:131], v[100:103], v[36:39], v[128:131]
    ds_read_b128 v[60:63], v8 offset:14336
    v_mfma_f32_16x16x32_bf16 v[132:135], v[104:107], v[32:35], v[132:135]
    v_mfma_f32_16x16x32_bf16 v[132:135], v[108:111], v[36:39], v[132:135]
    s_add_u32 s56, s56, 16384
    v_mfma_f32_16x16x32_bf16 v[136:139], v[112:115], v[32:35], v[136:139]
    s_and_b32 s56, s56, 65535
    v_mfma_f32_16x16x32_bf16 v[136:139], v[116:119], v[36:39], v[136:139]
    v_add_u32 v10, s56, v4
    v_mfma_f32_16x16x32_bf16 v[140:143], v[120:123], v[32:35], v[140:143]
    v_xor_b32 v12, 64, v10
    v_mfma_f32_16x16x32_bf16 v[140:143], v[124:127], v[36:39], v[140:143]
    s_waitcnt lgkmcnt(5)
    v_mfma_f32_16x16x32_bf16 v[156:159], v[120:123], v[36:39], v[156:159]
    v_mfma_f32_16x16x32_bf16 v[156:159], v[124:127], v[40:43], v[156:159]
    v_mfma_f32_16x16x32_bf16 v[152:155], v[112:115], v[36:39], v[152:155]
    v_mfma_f32_16x16x32_bf16 v[152:155], v[116:119], v[40:43], v[152:155]
    v_mfma_f32_16x16x32_bf16 v[148:151], v[104:107], v[36:39], v[148:151]
    v_mfma_f32_16x16x32_bf16 v[148:151], v[108:111], v[40:43], v[148:151]
    v_mfma_f32_16x16x32_bf16 v[144:147], v[96:99], v[36:39], v[144:147]
    v_mfma_f32_16x16x32_bf16 v[144:147], v[100:103], v[40:43], v[144:147]
    s_waitcnt lgkmcnt(4)
    v_mfma_f32_16x16x32_bf16 v[160:163], v[96:99], v[40:43], v[160:163]
    v_mfma_f32_16x16x32_bf16 v[160:163], v[100:103], v[44:47], v[160:163]
    v_mfma_f32_16x16x32_bf16 v[164:167], v[104:107], v[40:43], v[164:167]
    v_mfma_f32_16x16x32_bf16 v[164:167], v[108:111], v[44:47], v[164:167]
    v_mfma_f32_16x16x32_bf16 v[168:171], v[112:115], v[40:43], v[168:171]
    v_mfma_f32_16x16x32_bf16 v[168:171], v[116:119], v[44:47], v[168:171]
    v_mfma_f32_16x16x32_bf16 v[172:175], v[120:123], v[40:43], v[172:175]
    v_mfma_f32_16x16x32_bf16 v[172:175], v[124:127], v[44:47], v[172:175]
    s_waitcnt lgkmcnt(3)
    v_mfma_f32_16x16x32_bf16 v[188:191], v[120:123], v[44:47], v[188:191]
    v_mfma_f32_16x16x32_bf16 v[188:191], v[124:127], v[48:51], v[188:191]
    v_mfma_f32_16x16x32_bf16 v[184:187], v[112:115], v[44:47], v[184:187]
    v_mfma_f32_16x16x32_bf16 v[184:187], v[116:119], v[48:51], v[184:187]
    v_mfma_f32_16x16x32_bf16 v[180:183], v[104:107], v[44:47], v[180:183]
    v_mfma_f32_16x16x32_bf16 v[180:183], v[108:111], v[48:51], v[180:183]
    s_cmp_eq_u32 s57, s75
    v_mfma_f32_16x16x32_bf16 v[176:179], v[96:99], v[44:47], v[176:179]
    s_cbranch_scc1 L_count
L_count_back:
    v_mfma_f32_16x16x32_bf16 v[176:179], v[100:103], v[48:51], v[176:179]
    s_waitcnt lgkmcnt(2)
    v_mfma_f32_16x16x32_bf16 v[192:195], v[96:99], v[48:51], v[192:195]
    ds_read_b128 v[44:47], v11 offset:0
    v_mfma_f32_16x16x32_bf16 v[192:195], v[100:103], v[52:55], v[192:195]
    v_mfma_f32_16x16x32_bf16 v[196:199], v[104:107], v[48:51], v[196:199]
    v_mfma_f32_16x16x32_bf16 v[196:199], v[108:111], v[52:55], v[196:199]
    v_mfma_f32_16x16x32_bf16 v[200:203], v[112:115], v[48:51], v[200:203]
    v_mfma_f32_16x16x32_bf16 v[200:203], v[116:119], v[52:55], v[200:203]
    v_mfma_f32_16x16x32_bf16 v[204:207], v[120:123], v[48:51], v[204:207]
    v_mfma_f32_16x16x32_bf16 v[204:207], v[124:127], v[52:55], v[204:207]
    s_waitcnt lgkmcnt(0)
    v_mfma_f32_16x16x32_bf16 v[220:223], v[120:123], v[52:55], v[220:223]
    s_barrier
    v_mfma_f32_16x16x32_bf16 v[220:223], v[124:127], v[56:59], v[220:223]
    ds_read_b128 v[32:35], v9 offset:0
    v_mfma_f32_16x16x32_bf16 v[216:219], v[112:115], v[52:55], v[216:219]
    ds_read_b128 v[36:39], v9 offset:2048
    v_mfma_f32_16x16x32_bf16 v[216:219], v[116:119], v[56:59], v[216:219]
    ds_read_b64_tr_b16 v[64:65], v10 offset:0
    v_mfma_f32_16x16x32_bf16 v[212:215], v[104:107], v[52:55], v[212:215]
    ds_read_b64_tr_b16 v[66:67], v10 offset:1024
    v_mfma_f32_16x16x32_bf16 v[212:215], v[108:111], v[56:59], v[212:215]
    ds_read_b64_tr_b16 v[68:69], v10 offset:8192
    v_mfma_f32_16x16x32_bf16 v[208:211], v[96:99], v[52:55], v[208:211]
    ds_read_b64_tr_b16 v[70:71], v10 offset:9216
    v_mfma_f32_16x16x32_bf16 v[208:211], v[100:103], v[56:59], v[208:211]
    ds_read_b64_tr_b16 v[72:73], v10 offset:8
    v_mfma_f32_16x16x32_bf16 v[224:227], v[96:99], v[56:59], v[224:227]
    ds_read_b64_tr_b16 v[74:75], v10 offset:1032
    v_mfma_f32_16x16x32_bf16 v[224:227], v[100:103], v[60:63], v[224:227]
    ds_read_b64_tr_b16 v[76:77], v10 offset:8200
    v_mfma_f32_16x16x32_bf16 v[228:231], v[104:107], v[56:59], v[228:231]
    ds_read_b64_tr_b16 v[78:79], v10 offset:9224
    v_mfma_f32_16x16x32_bf16 v[228:231], v[108:111], v[60:63], v[228:231]
    ds_read_b64_tr_b16 v[80:81], v12 offset:0
    v_mfma_f32_16x16x32_bf16 v[232:235], v[112:115], v[56:59], v[232:235]
    ds_read_b64_tr_b16 v[82:83], v12 offset:1024
    v_mfma_f32_16x16x32_bf16 v[232:235], v[116:119], v[60:63], v[232:235]
    ds_read_b64_tr_b16 v[84:85], v12 offset:8192
    v_mfma_f32_16x16x32_bf16 v[236:239], v[120:123], v[56:59], v[236:239]
    ds_read_b64_tr_b16 v[86:87], v12 offset:9216
    v_mfma_f32_16x16x32_bf16 v[236:239], v[124:127], v[60:63], v[236:239]
    ds_read_b64_tr_b16 v[88:89], v12 offset:8
    v_mfma_f32_16x16x32_bf16 v[252:255], v[120:123], v[60:63], v[252:255]
    ds_read_b64_tr_b16 v[90:91], v12 offset:1032
    v_mfma_f32_16x16x32_bf16 v[252:255], v[124:127], v[44:47], v[252:255]
    ds_read_b64_tr_b16 v[92:93], v12 offset:8200
    v_mfma_f32_16x16x32_bf16 v[248:251], v[112:115], v[60:63], v[248:251]
    ds_read_b64_tr_b16 v[94:95], v12 offset:9224
    v_mfma_f32_16x16x32_bf16 v[248:251], v[116:119], v[44:47], v[248:251]
    ds_read_b128 v[40:43], v9 offset:4096
    v_mfma_f32_16x16x32_bf16 v[244:247], v[104:107], v[60:63], v[244:247]
    ds_read_b128 v[48:51], v9 offset:8192
    v_mfma_f32_16x16x32_bf16 v[244:247], v[108:111], v[44:47], v[244:247]
    ds_read_b128 v[52:55], v9 offset:10240
    v_mfma_f32_16x16x32_bf16 v[240:243], v[96:99], v[60:63], v[240:243]
    v_mfma_f32_16x16x32_bf16 v[240:243], v[100:103], v[44:47], v[240:243]
    s_waitcnt lgkmcnt(3)
    v_mfma_f32_16x16x32_bf16 v[128:131], v[64:67], v[32:35], v[128:131]
    ds_read_b128 v[44:47], v9 offset:6144
    v_mfma_f32_16x16x32_bf16 v[128:131], v[68:71], v[36:39], v[128:131]
    ds_read_b128 v[56:59], v9 offset:12288
    v_mfma_f32_16x16x32_bf16 v[132:135], v[72:75], v[32:35], v[132:135]
    ds_read_b128 v[60:63], v9 offset:14336
    v_mfma_f32_16x16x32_bf16 v[132:135], v[76:79], v[36:39], v[132:135]
    s_add_u32 s56, s56, 16384
    v_mfma_f32_16x16x32_bf16 v[136:139], v[80:83], v[32:35], v[136:139]
    s_and_b32 s56, s56, 65535
    v_mfma_f32_16x16x32_bf16 v[136:139], v[84:87], v[36:39], v[136:139]
    s_add_u32 s55, s55, 32768
    v_mfma_f32_16x16x32_bf16 v[140:143], v[88:91], v[32:35], v[140:143]
    s_cmp_eq_u32 s55, 163840
    v_mfma_f32_16x16x32_bf16 v[140:143], v[92:95], v[36:39], v[140:143]
    s_waitcnt lgkmcnt(5)
    v_mfma_f32_16x16x32_bf16 v[156:159], v[88:91], v[36:39], v[156:159]
    v_mfma_f32_16x16x32_bf16 v[156:159], v[92:95], v[40:43], v[156:159]
    v_mfma_f32_16x16x32_bf16 v[152:155], v[80:83], v[36:39], v[152:155]
    v_mfma_f32_16x16x32_bf16 v[152:155], v[84:87], v[40:43], v[152:155]
    s_cselect_b32 s55, 65536, s55
    v_mfma_f32_16x16x32_bf16 v[148:151], v[72:75], v[36:39], v[148:151]
    v_add_u32 v10, s56, v4
    v_mfma_f32_16x16x32_bf16 v[148:151], v[76:79], v[40:43], v[148:151]
    v_xor_b32 v12, 64, v10
    v_mfma_f32_16x16x32_bf16 v[144:147], v[64:67], v[36:39], v[144:147]
    v_mfma_f32_16x16x32_bf16 v[144:147], v[68:71], v[40:43], v[144:147]
    s_waitcnt lgkmcnt(2)
    v_mfma_f32_16x16x32_bf16 v[160:163], v[64:67], v[40:43], v[160:163]
    v_mfma_f32_16x16x32_bf16 v[160:163], v[68:71], v[44:47], v[160:163]
    v_mfma_f32_16x16x32_bf16 v[164:167], v[72:75], v[40:43], v[164:167]
    v_mfma_f32_16x16x32_bf16 v[164:167], v[76:79], v[44:47], v[164:167]
    v_mfma_f32_16x16x32_bf16 v[168:171], v[80:83], v[40:43], v[168:171]
    v_mfma_f32_16x16x32_bf16 v[168:171], v[84:87], v[44:47], v[168:171]
    v_mfma_f32_16x16x32_bf16 v[172:175], v[88:91], v[40:43], v[172:175]
    v_mfma_f32_16x16x32_bf16 v[172:175], v[92:95], v[44:47], v[172:175]
    v_mfma_f32_16x16x32_bf16 v[188:191], v[88:91], v[44:47], v[188:191]
    v_mfma_f32_16x16x32_bf16 v[188:191], v[92:95], v[48:51], v[188:191]
    v_mfma_f32_16x16x32_bf16 v[184:187], v[80:83], v[44:47], v[184:187]
    v_mfma_f32_16x16x32_bf16 v[184:187], v[84:87], v[48:51], v[184:187]
    v_mfma_f32_16x16x32_bf16 v[180:183], v[72:75], v[44:47], v[180:183]
    v_mfma_f32_16x16x32_bf16 v[180:183], v[76:79], v[48:51], v[180:183]
    v_mfma_f32_16x16x32_bf16 v[176:179], v[64:67], v[44:47], v[176:179]
    v_mfma_f32_16x16x32_bf16 v[176:179], v[68:71], v[48:51], v[176:179]
    v_mfma_f32_16x16x32_bf16 v[192:195], v[64:67], v[48:51], v[192:195]
    ds_read_b128 v[44:47], v13 offset:0
    v_mfma_f32_16x16x32_bf16 v[192:195], v[68:71], v[52:55], v[192:195]
    v_mfma_f32_16x16x32_bf16 v[196:199], v[72:75], v[48:51], v[196:199]
    v_add_u32 v8, s55, v2
    v_mfma_f32_16x16x32_bf16 v[196:199], v[76:79], v[52:55], v[196:199]
    v_xor_b32 v9, 64, v8
    v_mfma_f32_16x16x32_bf16 v[200:203], v[80:83], v[48:51], v[200:203]
    v_mfma_f32_16x16x32_bf16 v[200:203], v[84:87], v[52:55], v[200:203]
    v_mfma_f32_16x16x32_bf16 v[204:207], v[88:91], v[48:51], v[204:207]
    v_mfma_f32_16x16x32_bf16 v[204:207], v[92:95], v[52:55], v[204:207]
    s_waitcnt lgkmcnt(0)
    v_mfma_f32_16x16x32_bf16 v[220:223], v[88:91], v[52:55], v[220:223]
    s_barrier
    v_mfma_f32_16x16x32_bf16 v[220:223], v[92:95], v[56:59], v[220:223]
    ds_read_b128 v[32:35], v8 offset:0
    v_mfma_f32_16x16x32_bf16 v[216:219], v[80:83], v[52:55], v[216:219]
    ds_read_b128 v[36:39], v9 offset:0
    v_mfma_f32_16x16x32_bf16 v[216:219], v[84:87], v[56:59], v[216:219]
    ds_read_b64_tr_b16 v[96:97], v10 offset:0
    v_mfma_f32_16x16x32_bf16 v[212:215], v[72:75], v[52:55], v[212:215]
    ds_read_b64_tr_b16 v[98:99], v10 offset:1024
    v_mfma_f32_16x16x32_bf16 v[212:215], v[76:79], v[56:59], v[212:215]
    ds_read_b64_tr_b16 v[100:101], v10 offset:8192
    v_mfma_f32_16x16x32_bf16 v[208:211], v[64:67], v[52:55], v[208:211]
    ds_read_b64_tr_b16 v[102:103], v10 offset:9216
    v_mfma_f32_16x16x32_bf16 v[208:211], v[68:71], v[56:59], v[208:211]
    ds_read_b64_tr_b16 v[104:105], v10 offset:8
    v_mfma_f32_16x16x32_bf16 v[224:227], v[64:67], v[56:59], v[224:227]
    ds_read_b64_tr_b16 v[106:107], v10 offset:1032
    v_mfma_f32_16x16x32_bf16 v[224:227], v[68:71], v[60:63], v[224:227]
    ds_read_b64_tr_b16 v[108:109], v10 offset:8200
    v_mfma_f32_16x16x32_bf16 v[228:231], v[72:75], v[56:59], v[228:231]
    ds_read_b64_tr_b16 v[110:111], v10 offset:9224
    v_mfma_f32_16x16x32_bf16 v[228:231], v[76:79], v[60:63], v[228:231]
    ds_read_b64_tr_b16 v[112:113], v12 offset:0
    v_mfma_f32_16x16x32_bf16 v[232:235], v[80:83], v[56:59], v[232:235]
    ds_read_b64_tr_b16 v[114:115], v12 offset:1024
    v_mfma_f32_16x16x32_bf16 v[232:235], v[84:87], v[60:63], v[232:235]
    ds_read_b64_tr_b16 v[116:117], v12 offset:8192
    v_mfma_f32_16x16x32_bf16 v[236:239], v[88:91], v[56:59], v[236:239]
    ds_read_b64_tr_b16 v[118:119], v12 offset:9216
    v_mfma_f32_16x16x32_bf16 v[236:239], v[92:95], v[60:63], v[236:239]
    ds_read_b64_tr_b16 v[120:121], v12 offset:8
    v_mfma_f32_16x16x32_bf16 v[252:255], v[88:91], v[60:63], v[252:255]
    ds_read_b64_tr_b16 v[122:123], v12 offset:1032
    v_mfma_f32_16x16x32_bf16 v[252:255], v[92:95], v[44:47], v[252:255]
    ds_read_b64_tr_b16 v[124:125], v12 offset:8200
    v_mfma_f32_16x16x32_bf16 v[248:251], v[80:83], v[60:63], v[248:251]
    ds_read_b64_tr_b16 v[126:127], v12 offset:9224
    v_mfma_f32_16x16x32_bf16 v[248:251], v[84:87], v[44:47], v[248:251]
    ds_read_b128 v[40:43], v8 offset:2048
    v_mfma_f32_16x16x32_bf16 v[244:247], v[72:75], v[60:63], v[244:247]
    ds_read_b128 v[48:51], v8 offset:4096
    v_mfma_f32_16x16x32_bf16 v[244:247], v[76:79], v[44:47], v[244:247]
    ds_read_b128 v[52:55], v9 offset:4096
    v_mfma_f32_16x16x32_bf16 v[240:243], v[64:67], v[60:63], v[240:243]
    v_mfma_f32_16x16x32_bf16 v[240:243], v[68:71], v[44:47], v[240:243]
    s_waitcnt lgkmcnt(3)
    v_mfma_f32_16x16x32_bf16 v[128:131], v[96:99], v[32:35], v[128:131]
    ds_read_b128 v[44:47], v9 offset:2048
    v_mfma_f32_16x16x32_bf16 v[128:131], v[100:103], v[36:39], v[128:131]
    ds_read_b128 v[56:59], v8 offset:6144
    v_mfma_f32_16x16x32_bf16 v[132:135], v[104:107], v[32:35], v[132:135]
    ds_read_b128 v[60:63], v9 offset:6144
    v_mfma_f32_16x16x32_bf16 v[132:135], v[108:111], v[36:39], v[132:135]
    s_add_u32 s57, s57, 1
    v_mfma_f32_16x16x32_bf16 v[136:139], v[112:115], v[32:35], v[136:139]
    s_add_u32 s56, s56, 16384
    v_mfma_f32_16x16x32_bf16 v[136:139], v[116:119], v[36:39], v[136:139]
    s_and_b32 s56, s56, 65535
    v_mfma_f32_16x16x32_bf16 v[140:143], v[120:123], v[32:35], v[140:143]
    s_add_u32 s55, s55, 32768
    v_mfma_f32_16x16x32_bf16 v[140:143], v[124:127], v[36:39], v[140:143]
    s_waitcnt lgkmcnt(2)
    v_mfma_f32_16x16x32_bf16 v[156:159], v[120:123], v[40:43], v[156:159]
    ds_read_b128 v[32:35], v8 offset:8192
    v_mfma_f32_16x16x32_bf16 v[156:159], v[124:127], v[44:47], v[156:159]
    ds_read_b128 v[36:39], v9 offset:8192
    v_mfma_f32_16x16x32_bf16 v[152:155], v[112:115], v[40:43], v[152:155]
    v_mfma_f32_16x16x32_bf16 v[152:155], v[116:119], v[44:47], v[152:155]
    s_cmp_eq_u32 s55, 163840
    v_mfma_f32_16x16x32_bf16 v[148:151], v[104:107], v[40:43], v[148:151]
    s_cselect_b32 s55, 65536, s55
    v_mfma_f32_16x16x32_bf16 v[148:151], v[108:111], v[44:47], v[148:151]
    v_add_u32 v10, s56, v4
    v_mfma_f32_16x16x32_bf16 v[144:147], v[96:99], v[40:43], v[144:147]
    v_xor_b32 v12, 64, v10
    v_mfma_f32_16x16x32_bf16 v[144:147], v[100:103], v[44:47], v[144:147]
    v_mfma_f32_16x16x32_bf16 v[160:163], v[96:99], v[48:51], v[160:163]
    ds_read_b128 v[40:43], v8 offset:10240
    v_mfma_f32_16x16x32_bf16 v[160:163], v[100:103], v[52:55], v[160:163]
    ds_read_b128 v[44:47], v9 offset:10240
    v_mfma_f32_16x16x32_bf16 v[164:167], v[104:107], v[48:51], v[164:167]
    v_mfma_f32_16x16x32_bf16 v[164:167], v[108:111], v[52:55], v[164:167]
    v_mfma_f32_16x16x32_bf16 v[168:171], v[112:115], v[48:51], v[168:171]
    v_mfma_f32_16x16x32_bf16 v[168:171], v[116:119], v[52:55], v[168:171]
    v_mfma_f32_16x16x32_bf16 v[172:175], v[120:123], v[48:51], v[172:175]
    v_mfma_f32_16x16x32_bf16 v[172:175], v[124:127], v[52:55], v[172:175]
    s_waitcnt lgkmcnt(4)
    v_mfma_f32_16x16x32_bf16 v[188:191], v[120:123], v[56:59], v[188:191]
    ds_read_b128 v[48:51], v8 offset:12288
    v_mfma_f32_16x16x32_bf16 v[188:191], v[124:127], v[60:63], v[188:191]
    ds_read_b128 v[52:55], v9 offset:12288
    v_mfma_f32_16x16x32_bf16 v[184:187], v[112:115], v[56:59], v[184:187]
    v_mfma_f32_16x16x32_bf16 v[184:187], v[116:119], v[60:63], v[184:187]
    v_mfma_f32_16x16x32_bf16 v[180:183], v[104:107], v[56:59], v[180:183]
    v_mfma_f32_16x16x32_bf16 v[180:183], v[108:111], v[60:63], v[180:183]
    v_mfma_f32_16x16x32_bf16 v[176:179], v[96:99], v[56:59], v[176:179]
    v_mfma_f32_16x16x32_bf16 v[176:179], v[100:103], v[60:63], v[176:179]
    s_waitcnt lgkmcnt(4)
    v_mfma_f32_16x16x32_bf16 v[192:195], v[96:99], v[32:35], v[192:195]
    ds_read_b128 v[56:59], v8 offset:14336
    v_mfma_f32_16x16x32_bf16 v[192:195], v[100:103], v[36:39], v[192:195]
    ds_read_b128 v[60:63], v9 offset:14336
    v_mfma_f32_16x16x32_bf16 v[196:199], v[104:107], v[32:35], v[196:199]
    v_add_u32 v8, s55, v2
    v_mfma_f32_16x16x32_bf16 v[196:199], v[108:111], v[36:39], v[196:199]
    v_xor_b32 v9, 64, v8
    v_mfma_f32_16x16x32_bf16 v[200:203], v[112:115], v[32:35], v[200:203]
    v_add_u32 v11, s55, v3
    v_mfma_f32_16x16x32_bf16 v[200:203], v[116:119], v[36:39], v[200:203]
    v_xor_b32 v13, 64, v11
    v_mfma_f32_16x16x32_bf16 v[204:207], v[120:123], v[32:35], v[204:207]
    v_mfma_f32_16x16x32_bf16 v[204:207], v[124:127], v[36:39], v[204:207]
    s_waitcnt lgkmcnt(0)
    v_mfma_f32_16x16x32_bf16 v[220:223], v[120:123], v[40:43], v[220:223]
    s_barrier
    v_mfma_f32_16x16x32_bf16 v[220:223], v[124:127], v[44:47], v[220:223]
    ds_read_b128 v[32:35], v8 offset:0
    v_mfma_f32_16x16x32_bf16 v[216:219], v[112:115], v[40:43], v[216:219]
    ds_read_b128 v[36:39], v8 offset:2048
    v_mfma_f32_16x16x32_bf16 v[216:219], v[116:119], v[44:47], v[216:219]
    ds_read_b64_tr_b16 v[64:65], v10 offset:0
    v_mfma_f32_16x16x32_bf16 v[212:215], v[104:107], v[40:43], v[212:215]
    ds_read_b64_tr_b16 v[66:67], v10 offset:1024
    v_mfma_f32_16x16x32_bf16 v[212:215], v[108:111], v[44:47], v[212:215]
    ds_read_b64_tr_b16 v[68:69], v10 offset:8192
    v_mfma_f32_16x16x32_bf16 v[208:211], v[96:99], v[40:43], v[208:211]
    ds_read_b64_tr_b16 v[70:71], v10 offset:9216
    v_mfma_f32_16x16x32_bf16 v[208:211], v[100:103], v[44:47], v[208:211]
    ds_read_b64_tr_b16 v[72:73], v10 offset:8
    v_mfma_f32_16x16x32_bf16 v[224:227], v[96:99], v[48:51], v[224:227]
    ds_read_b64_tr_b16 v[74:75], v10 offset:1032
    v_mfma_f32_16x16x32_bf16 v[224:227], v[100:103], v[52:55], v[224:227]
    ds_read_b64_tr_b16 v[76:77], v10 offset:8200
    v_mfma_f32_16x16x32_bf16 v[228:231], v[104:107], v[48:51], v[228:231]
    ds_read_b64_tr_b16 v[78:79], v10 offset:9224
    v_mfma_f32_16x16x32_bf16 v[228:231], v[108:111], v[52:55], v[228:231]
    ds_read_b64_tr_b16 v[80:81], v12 offset:0
    v_mfma_f32_16x16x32_bf16 v[232:235], v[112:115], v[48:51], v[232:235]
    ds_read_b64_tr_b16 v[82:83], v12 offset:1024
    v_mfma_f32_16x16x32_bf16 v[232:235], v[116:119], v[52:55], v[232:235]
    ds_read_b64_tr_b16 v[84:85], v12 offset:8192
    v_mfma_f32_16x16x32_bf16 v[236:239], v[120:123], v[48:51], v[236:239]
    ds_read_b64_tr_b16 v[86:87], v12 offset:9216
    v_mfma_f32_16x16x32_bf16 v[236:239], v[124:127], v[52:55], v[236:239]
    ds_read_b64_tr_b16 v[88:89], v12 offset:8
    v_mfma_f32_16x16x32_bf16 v[252:255], v[120:123], v[56:59], v[252:255]
    ds_read_b64_tr_b16 v[90:91], v12 offset:1032
    v_mfma_f32_16x16x32_bf16 v[252:255], v[124:127], v[60:63], v[252:255]
    ds_read_b64_tr_b16 v[92:93], v12 offset:8200
    v_mfma_f32_16x16x32_bf16 v[248:251], v[112:115], v[56:59], v[248:251]
    ds_read_b64_tr_b16 v[94:95], v12 offset:9224
    v_mfma_f32_16x16x32_bf16 v[248:251], v[116:119], v[60:63], v[248:251]
    ds_read_b128 v[40:43], v8 offset:4096
    v_mfma_f32_16x16x32_bf16 v[244:247], v[104:107], v[56:59], v[244:247]
    ds_read_b128 v[44:47], v8 offset:6144
    v_mfma_f32_16x16x32_bf16 v[244:247], v[108:111], v[60:63], v[244:247]
    ds_read_b128 v[48:51], v8 offset:8192
    v_mfma_f32_16x16x32_bf16 v[240:243], v[96:99], v[56:59], v[240:243]
    ds_read_b128 v[52:55], v8 offset:10240
    v_mfma_f32_16x16x32_bf16 v[240:243], v[100:103], v[60:63], v[240:243]
    s_branch L_c_loop
L_tail:
    s_waitcnt lgkmcnt(11)
    v_mfma_f32_16x16x32_bf16 v[128:131], v[64:67], v[32:35], v[128:131]
    ds_read_b128 v[44:47], v9 offset:2048
    v_add_u32 v6, 65536, v2
    v_mfma_f32_16x16x32_bf16 v[128:131], v[68:71], v[36:39], v[128:131]
    ds_read_b128 v[56:59], v8 offset:6144
    v_add_u32 v2, 131072, v2
    v_mfma_f32_16x16x32_bf16 v[132:135], v[72:75], v[32:35], v[132:135]
    ds_read_b128 v[60:63], v9 offset:6144
    v_add_u32 v3, 131072, v3
    v_mfma_f32_16x16x32_bf16 v[132:135], v[76:79], v[36:39], v[132:135]
    v_xor_b32 v7, 64, v6
    s_waitcnt lgkmcnt(2)
    v_mfma_f32_16x16x32_bf16 v[148:151], v[72:75], v[40:43], v[148:151]
    ds_read_b128 v[32:35], v8 offset:8192
    v_xor_b32 v15, 64, v2
    v_mfma_f32_16x16x32_bf16 v[148:151], v[76:79], v[44:47], v[148:151]
    ds_read_b128 v[36:39], v9 offset:8192
    v_xor_b32 v11, 64, v3
    v_mfma_f32_16x16x32_bf16 v[144:147], v[64:67], v[40:43], v[144:147]
    s_mul_i32 s52, s50, 7999
    s_mul_i32 s53, s49, 250
    v_mfma_f32_16x16x32_bf16 v[144:147], v[68:71], v[44:47], v[144:147]
    s_add_u32 s52, s52, s53
    v_mfma_f32_16x16x32_bf16 v[160:163], v[64:67], v[48:51], v[160:163]
    ds_read_b128 v[40:43], v8 offset:10240
    s_lshl_b32 s52, s52, 10
    v_mfma_f32_16x16x32_bf16 v[160:163], v[68:71], v[52:55], v[160:163]
    ds_read_b128 v[44:47], v9 offset:10240
    s_lshl_b32 s53, s48, 8
    v_mfma_f32_16x16x32_bf16 v[164:167], v[72:75], v[48:51], v[164:167]
    s_add_u32 s52, s52, s53
    s_add_u32 s28, s12, s52
    v_mfma_f32_16x16x32_bf16 v[164:167], v[76:79], v[52:55], v[164:167]
    s_addc_u32 s29, s13, 0
    s_waitcnt lgkmcnt(4)
    v_mfma_f32_16x16x32_bf16 v[180:183], v[72:75], v[56:59], v[180:183]
    ds_read_b128 v[48:51], v8 offset:12288
    s_cmp_eq_u32 s49, 31
    v_mfma_f32_16x16x32_bf16 v[180:183], v[76:79], v[60:63], v[180:183]
    ds_read_b128 v[52:55], v9 offset:12288
    s_cselect_b32 s30, 0, 1024
    v_mfma_f32_16x16x32_bf16 v[176:179], v[64:67], v[56:59], v[176:179]
    ds_read_b64_tr_b16 v[96:97], v10 offset:16384
    s_cselect_b32 s40, 0xfff7fff7, -1
    v_mfma_f32_16x16x32_bf16 v[176:179], v[68:71], v[60:63], v[176:179]
    ds_read_b64_tr_b16 v[98:99], v10 offset:17408
    s_waitcnt lgkmcnt(6)
    v_mfma_f32_16x16x32_bf16 v[192:195], v[64:67], v[32:35], v[192:195]
    ds_read_b128 v[56:59], v8 offset:14336
    s_add_u32 s30, s30, 254208
    v_mfma_f32_16x16x32_bf16 v[192:195], v[68:71], v[36:39], v[192:195]
    ds_read_b128 v[60:63], v9 offset:14336
    s_mov_b32 s31, 0x00020000
    v_mfma_f32_16x16x32_bf16 v[196:199], v[72:75], v[32:35], v[196:199]
    ds_read_b64_tr_b16 v[100:101], v10 offset:24576
    s_cmp_eq_u32 s59, 1
    v_mfma_f32_16x16x32_bf16 v[196:199], v[76:79], v[36:39], v[196:199]
    ds_read_b64_tr_b16 v[102:103], v10 offset:25600
    s_waitcnt lgkmcnt(8)
    v_mfma_f32_16x16x32_bf16 v[212:215], v[72:75], v[40:43], v[212:215]
    ds_read_b128 v[32:35], v2 offset:0
    s_cselect_b32 s40, s40, -1
    v_mfma_f32_16x16x32_bf16 v[212:215], v[76:79], v[44:47], v[212:215]
    ds_read_b128 v[36:39], v2 offset:2048
    s_cselect_b32 s44, 0xfff7fff7, -1
    v_mfma_f32_16x16x32_bf16 v[208:211], v[64:67], v[40:43], v[208:211]
    ds_read_b64_tr_b16 v[104:105], v10 offset:16392
    s_mov_b32 s41, s40
    v_mfma_f32_16x16x32_bf16 v[208:211], v[68:71], v[44:47], v[208:211]
    ds_read_b64_tr_b16 v[106:107], v10 offset:17416
    s_waitcnt lgkmcnt(10)
    v_mfma_f32_16x16x32_bf16 v[224:227], v[64:67], v[48:51], v[224:227]
    ds_read_b128 v[40:43], v2 offset:4096
    s_mov_b32 s45, s44
    v_mfma_f32_16x16x32_bf16 v[224:227], v[68:71], v[52:55], v[224:227]
    s_mov_b32 s42, 0x11111111
    s_mov_b32 s43, 0x11111111
    v_mfma_f32_16x16x32_bf16 v[228:231], v[72:75], v[48:51], v[228:231]
    ds_read_b64_tr_b16 v[108:109], v10 offset:24584
    s_mov_b32 s46, 0x409d30fc
    v_mfma_f32_16x16x32_bf16 v[228:231], v[76:79], v[52:55], v[228:231]
    ds_read_b64_tr_b16 v[110:111], v10 offset:25608
    s_waitcnt lgkmcnt(9)
    v_mfma_f32_16x16x32_bf16 v[244:247], v[72:75], v[56:59], v[244:247]
    ds_read_b128 v[44:47], v2 offset:6144
    s_mov_b32 s47, 0x3eeff558
    v_mfma_f32_16x16x32_bf16 v[244:247], v[76:79], v[60:63], v[244:247]
    s_movk_i32 s64, 4096
    v_bfe_u32 v24, v0, 2, 2
    v_mfma_f32_16x16x32_bf16 v[240:243], v[64:67], v[56:59], v[240:243]
    v_lshlrev_b32 v24, 6, v24
    v_lshrrev_b32 v25, 4, v0
    v_mfma_f32_16x16x32_bf16 v[240:243], v[68:71], v[60:63], v[240:243]
    v_lshl_add_u32 v14, v25, 4, v24
    s_waitcnt lgkmcnt(1)
    v_mfma_f32_16x16x32_bf16 v[128:131], v[96:99], v[32:35], v[128:131]
    ds_read_b128 v[48:51], v2 offset:8192
    s_lshl_b32 s53, s49, 10
    v_mfma_f32_16x16x32_bf16 v[128:131], v[100:103], v[36:39], v[128:131]
    s_lshl_b32 s54, s51, 8
    s_add_u32 s53, s53, s54
    v_mfma_f32_16x16x32_bf16 v[132:135], v[104:107], v[32:35], v[132:135]
    v_add_u32 v14, s53, v14
    s_lshl_b32 s53, s60, 11
    v_mfma_f32_16x16x32_bf16 v[132:135], v[108:111], v[36:39], v[132:135]
    s_add_u32 s53, s53, 92032
    v_mfma_f32_16x16x32_bf16 v[148:151], v[104:107], v[36:39], v[148:151]
    ds_read_b128 v[52:55], v2 offset:10240
    v_lshl_add_u32 v5, v25, 4, s53
    v_mfma_f32_16x16x32_bf16 v[148:151], v[108:111], v[40:43], v[148:151]
    v_lshlrev_b32 v25, 4, v25
    v_lshl_add_u32 v25, v1, 13, v25
    v_mfma_f32_16x16x32_bf16 v[144:147], v[96:99], v[36:39], v[144:147]
    s_lshl_b32 s52, s59, 17
    s_lshl_b32 s53, s60, 7
    v_mfma_f32_16x16x32_bf16 v[144:147], v[100:103], v[40:43], v[144:147]
    s_add_u32 s52, s52, s53
    s_waitcnt lgkmcnt(2)
    v_mfma_f32_16x16x32_bf16 v[160:163], v[96:99], v[40:43], v[160:163]
    ds_read_b128 v[56:59], v2 offset:12288
    v_add_u32 v1, s52, v25
    v_mfma_f32_16x16x32_bf16 v[160:163], v[100:103], v[44:47], v[160:163]
    v_mfma_f32_16x16x32_bf16 v[164:167], v[104:107], v[40:43], v[164:167]
    v_mfma_f32_16x16x32_bf16 v[164:167], v[108:111], v[44:47], v[164:167]
    s_waitcnt lgkmcnt(2)
    v_mfma_f32_16x16x32_bf16 v[180:183], v[104:107], v[44:47], v[180:183]
    ds_read_b128 v[60:63], v2 offset:14336
    v_mfma_f32_16x16x32_bf16 v[180:183], v[108:111], v[48:51], v[180:183]
    v_mfma_f32_16x16x32_bf16 v[176:179], v[96:99], v[44:47], v[176:179]
    v_mfma_f32_16x16x32_bf16 v[176:179], v[100:103], v[48:51], v[176:179]
    s_barrier
    s_waitcnt lgkmcnt(2)
    v_mfma_f32_16x16x32_bf16 v[192:195], v[96:99], v[48:51], v[192:195]
    ds_read_b128 v[32:35], v3 offset:0
    v_mfma_f32_16x16x32_bf16 v[192:195], v[100:103], v[52:55], v[192:195]
    v_mfma_f32_16x16x32_bf16 v[196:199], v[104:107], v[48:51], v[196:199]
    ds_read_b64_tr_b16 v[112:113], v10 offset:32768
    v_mfma_f32_16x16x32_bf16 v[196:199], v[108:111], v[52:55], v[196:199]
    ds_read_b64_tr_b16 v[114:115], v10 offset:33792
    s_waitcnt lgkmcnt(4)
    v_mfma_f32_16x16x32_bf16 v[212:215], v[104:107], v[52:55], v[212:215]
    ds_read_b128 v[36:39], v15 offset:0
    v_mfma_f32_16x16x32_bf16 v[212:215], v[108:111], v[56:59], v[212:215]
    ds_read_b128 v[40:43], v15 offset:2048
    v_mfma_f32_16x16x32_bf16 v[208:211], v[96:99], v[52:55], v[208:211]
    ds_read_b64_tr_b16 v[116:117], v10 offset:40960
    v_mfma_f32_16x16x32_bf16 v[208:211], v[100:103], v[56:59], v[208:211]
    ds_read_b64_tr_b16 v[118:119], v10 offset:41984
    s_waitcnt lgkmcnt(7)
    v_mfma_f32_16x16x32_bf16 v[224:227], v[96:99], v[56:59], v[224:227]
    ds_read_b128 v[44:47], v15 offset:4096
    v_mfma_f32_16x16x32_bf16 v[224:227], v[100:103], v[60:63], v[224:227]
    v_mfma_f32_16x16x32_bf16 v[228:231], v[104:107], v[56:59], v[228:231]
    ds_read_b64_tr_b16 v[120:121], v10 offset:32776
    v_mfma_f32_16x16x32_bf16 v[228:231], v[108:111], v[60:63], v[228:231]
    ds_read_b64_tr_b16 v[122:123], v10 offset:33800
    s_waitcnt lgkmcnt(9)
    v_mfma_f32_16x16x32_bf16 v[244:247], v[104:107], v[60:63], v[244:247]
    ds_read_b128 v[48:51], v15 offset:6144
    v_mfma_f32_16x16x32_bf16 v[244:247], v[108:111], v[32:35], v[244:247]
    v_mfma_f32_16x16x32_bf16 v[240:243], v[96:99], v[60:63], v[240:243]
    ds_read_b64_tr_b16 v[124:125], v10 offset:40968
    v_mfma_f32_16x16x32_bf16 v[240:243], v[100:103], v[32:35], v[240:243]
    ds_read_b64_tr_b16 v[126:127], v10 offset:41992
    s_waitcnt lgkmcnt(0)
    v_mfma_f32_16x16x32_bf16 v[128:131], v[112:115], v[36:39], v[128:131]
    ds_read_b128 v[52:55], v15 offset:8192
    v_mfma_f32_16x16x32_bf16 v[128:131], v[116:119], v[40:43], v[128:131]
    v_mfma_f32_16x16x32_bf16 v[132:135], v[120:123], v[36:39], v[132:135]
    v_mfma_f32_16x16x32_bf16 v[132:135], v[124:127], v[40:43], v[132:135]
    v_mfma_f32_16x16x32_bf16 v[148:151], v[120:123], v[40:43], v[148:151]
    ds_read_b128 v[56:59], v15 offset:10240
    v_mfma_f32_16x16x32_bf16 v[148:151], v[124:127], v[44:47], v[148:151]
    v_mfma_f32_16x16x32_bf16 v[144:147], v[112:115], v[40:43], v[144:147]
    v_mfma_f32_16x16x32_bf16 v[144:147], v[116:119], v[44:47], v[144:147]
    v_mfma_f32_16x16x32_bf16 v[160:163], v[112:115], v[44:47], v[160:163]
    ds_read_b128 v[60:63], v15 offset:12288
    v_mfma_f32_16x16x32_bf16 v[160:163], v[116:119], v[48:51], v[160:163]
    v_mfma_f32_16x16x32_bf16 v[164:167], v[120:123], v[44:47], v[164:167]
    v_mfma_f32_16x16x32_bf16 v[164:167], v[124:127], v[48:51], v[164:167]
    s_waitcnt lgkmcnt(2)
    v_mfma_f32_16x16x32_bf16 v[180:183], v[120:123], v[48:51], v[180:183]
    ds_read_b128 v[32:35], v15 offset:14336
    v_mfma_f32_16x16x32_bf16 v[180:183], v[124:127], v[52:55], v[180:183]
    v_mfma_f32_16x16x32_bf16 v[176:179], v[112:115], v[48:51], v[176:179]
    v_mfma_f32_16x16x32_bf16 v[176:179], v[116:119], v[52:55], v[176:179]
    s_barrier
    s_waitcnt lgkmcnt(2)
    v_mfma_f32_16x16x32_bf16 v[192:195], v[112:115], v[52:55], v[192:195]
    ds_read_b128 v[36:39], v11 offset:0
    v_mfma_f32_16x16x32_bf16 v[192:195], v[116:119], v[56:59], v[192:195]
    v_mfma_f32_16x16x32_bf16 v[196:199], v[120:123], v[52:55], v[196:199]
    ds_read_b64_tr_b16 v[64:65], v10 offset:49152
    v_mfma_f32_16x16x32_bf16 v[196:199], v[124:127], v[56:59], v[196:199]
    ds_read_b64_tr_b16 v[66:67], v10 offset:50176
    s_waitcnt lgkmcnt(4)
    v_mfma_f32_16x16x32_bf16 v[212:215], v[120:123], v[56:59], v[212:215]
    ds_read_b128 v[40:43], v6 offset:0
    v_mfma_f32_16x16x32_bf16 v[212:215], v[124:127], v[60:63], v[212:215]
    ds_read_b128 v[44:47], v7 offset:0
    v_mfma_f32_16x16x32_bf16 v[208:211], v[112:115], v[56:59], v[208:211]
    ds_read_b64_tr_b16 v[68:69], v10 offset:57344
    v_mfma_f32_16x16x32_bf16 v[208:211], v[116:119], v[60:63], v[208:211]
    ds_read_b64_tr_b16 v[70:71], v10 offset:58368
    s_waitcnt lgkmcnt(7)
    v_mfma_f32_16x16x32_bf16 v[224:227], v[112:115], v[60:63], v[224:227]
    ds_read_b128 v[48:51], v6 offset:2048
    v_mfma_f32_16x16x32_bf16 v[224:227], v[116:119], v[32:35], v[224:227]
    ds_read_b128 v[52:55], v7 offset:2048
    v_mfma_f32_16x16x32_bf16 v[228:231], v[120:123], v[60:63], v[228:231]
    ds_read_b64_tr_b16 v[72:73], v10 offset:49160
    v_mfma_f32_16x16x32_bf16 v[228:231], v[124:127], v[32:35], v[228:231]
    ds_read_b64_tr_b16 v[74:75], v10 offset:50184
    s_waitcnt lgkmcnt(10)
    v_mfma_f32_16x16x32_bf16 v[244:247], v[120:123], v[32:35], v[244:247]
    ds_read_b128 v[56:59], v6 offset:4096
    v_mfma_f32_16x16x32_bf16 v[244:247], v[124:127], v[36:39], v[244:247]
    ds_read_b128 v[60:63], v7 offset:4096
    v_mfma_f32_16x16x32_bf16 v[240:243], v[112:115], v[32:35], v[240:243]
    ds_read_b64_tr_b16 v[76:77], v10 offset:57352
    v_mfma_f32_16x16x32_bf16 v[240:243], v[116:119], v[36:39], v[240:243]
    ds_read_b64_tr_b16 v[78:79], v10 offset:58376
    s_waitcnt lgkmcnt(0)
    v_mfma_f32_16x16x32_bf16 v[128:131], v[64:67], v[40:43], v[128:131]
    ds_read_b128 v[32:35], v6 offset:6144
    v_mfma_f32_16x16x32_bf16 v[128:131], v[68:71], v[44:47], v[128:131]
    ds_read_b128 v[36:39], v7 offset:6144
    v_mfma_f32_16x16x32_bf16 v[132:135], v[72:75], v[40:43], v[132:135]
    ds_read_b64_tr_b16 v[96:97], v12 offset:16384
    v_mfma_f32_16x16x32_bf16 v[132:135], v[76:79], v[44:47], v[132:135]
    ds_read_b64_tr_b16 v[98:99], v12 offset:17408
    v_mfma_f32_16x16x32_bf16 v[148:151], v[72:75], v[48:51], v[148:151]
    ds_read_b128 v[40:43], v6 offset:8192
    v_mfma_f32_16x16x32_bf16 v[148:151], v[76:79], v[52:55], v[148:151]
    ds_read_b128 v[44:47], v7 offset:8192
    v_mfma_f32_16x16x32_bf16 v[144:147], v[64:67], v[48:51], v[144:147]
    ds_read_b64_tr_b16 v[100:101], v12 offset:24576
    v_mfma_f32_16x16x32_bf16 v[144:147], v[68:71], v[52:55], v[144:147]
    ds_read_b64_tr_b16 v[102:103], v12 offset:25600
    v_mfma_f32_16x16x32_bf16 v[160:163], v[64:67], v[56:59], v[160:163]
    ds_read_b128 v[48:51], v6 offset:10240
    v_mfma_f32_16x16x32_bf16 v[160:163], v[68:71], v[60:63], v[160:163]
    ds_read_b128 v[52:55], v7 offset:10240
    v_mfma_f32_16x16x32_bf16 v[164:167], v[72:75], v[56:59], v[164:167]
    ds_read_b64_tr_b16 v[104:105], v12 offset:16392
    v_mfma_f32_16x16x32_bf16 v[164:167], v[76:79], v[60:63], v[164:167]
    ds_read_b64_tr_b16 v[106:107], v12 offset:17416
    s_waitcnt lgkmcnt(10)
    v_mfma_f32_16x16x32_bf16 v[180:183], v[72:75], v[32:35], v[180:183]
    ds_read_b128 v[56:59], v6 offset:12288
    v_mfma_f32_16x16x32_bf16 v[180:183], v[76:79], v[36:39], v[180:183]
    ds_read_b128 v[60:63], v7 offset:12288
    v_mfma_f32_16x16x32_bf16 v[176:179], v[64:67], v[32:35], v[176:179]
    ds_read_b64_tr_b16 v[108:109], v12 offset:24584
    v_mfma_f32_16x16x32_bf16 v[176:179], v[68:71], v[36:39], v[176:179]
    ds_read_b64_tr_b16 v[110:111], v12 offset:25608
    s_waitcnt lgkmcnt(10)
    v_mfma_f32_16x16x32_bf16 v[192:195], v[64:67], v[40:43], v[192:195]
    ds_read_b128 v[32:35], v6 offset:14336
    v_mfma_f32_16x16x32_bf16 v[192:195], v[68:71], v[44:47], v[192:195]
    ds_read_b128 v[36:39], v7 offset:14336
    v_mfma_f32_16x16x32_bf16 v[196:199], v[72:75], v[40:43], v[196:199]
    ds_read_b64_tr_b16 v[112:113], v12 offset:32768
    v_mfma_f32_16x16x32_bf16 v[196:199], v[76:79], v[44:47], v[196:199]
    ds_read_b64_tr_b16 v[114:115], v12 offset:33792
    s_waitcnt lgkmcnt(10)
    v_mfma_f32_16x16x32_bf16 v[212:215], v[72:75], v[48:51], v[212:215]
    ds_read_b128 v[40:43], v8 offset:0
    v_mfma_f32_16x16x32_bf16 v[212:215], v[76:79], v[52:55], v[212:215]
    ds_read_b128 v[44:47], v9 offset:0
    v_mfma_f32_16x16x32_bf16 v[208:211], v[64:67], v[48:51], v[208:211]
    ds_read_b64_tr_b16 v[116:117], v12 offset:40960
    v_mfma_f32_16x16x32_bf16 v[208:211], v[68:71], v[52:55], v[208:211]
    ds_read_b64_tr_b16 v[118:119], v12 offset:41984
    s_waitcnt lgkmcnt(10)
    v_mfma_f32_16x16x32_bf16 v[224:227], v[64:67], v[56:59], v[224:227]
    ds_read_b128 v[48:51], v2 offset:0
    v_mfma_f32_16x16x32_bf16 v[224:227], v[68:71], v[60:63], v[224:227]
    ds_read_b128 v[52:55], v2 offset:2048
    v_mfma_f32_16x16x32_bf16 v[228:231], v[72:75], v[56:59], v[228:231]
    ds_read_b64_tr_b16 v[120:121], v12 offset:32776
    v_mfma_f32_16x16x32_bf16 v[228:231], v[76:79], v[60:63], v[228:231]
    ds_read_b64_tr_b16 v[122:123], v12 offset:33800
    s_waitcnt lgkmcnt(10)
    v_mfma_f32_16x16x32_bf16 v[244:247], v[72:75], v[32:35], v[244:247]
    ds_read_b128 v[56:59], v15 offset:0
    v_mfma_f32_16x16x32_bf16 v[244:247], v[76:79], v[36:39], v[244:247]
    ds_read_b128 v[60:63], v15 offset:2048
    v_mfma_f32_16x16x32_bf16 v[240:243], v[64:67], v[32:35], v[240:243]
    ds_read_b64_tr_b16 v[124:125], v12 offset:40968
    v_mfma_f32_16x16x32_bf16 v[240:243], v[68:71], v[36:39], v[240:243]
    ds_read_b64_tr_b16 v[126:127], v12 offset:41992
    ds_read_b64_tr_b16 v[64:65], v12 offset:49152
    ds_read_b64_tr_b16 v[66:67], v12 offset:50176
    ds_read_b64_tr_b16 v[68:69], v12 offset:57344
    ds_read_b64_tr_b16 v[70:71], v12 offset:58368
    ds_read_b64_tr_b16 v[72:73], v12 offset:49160
    ds_read_b64_tr_b16 v[74:75], v12 offset:50184
    ds_read_b64_tr_b16 v[76:77], v12 offset:57352
    ds_read_b64_tr_b16 v[78:79], v12 offset:58376
    v_mov_b64 v[16:17], v[128:129]
    v_pk_mul_f32 v[20:21], v[128:129], v[128:129]
    v_mov_b64 v[18:19], v[130:131]
    v_pk_mul_f32 v[22:23], v[130:131], v[130:131]
    v_mov_b64 v[24:25], v[132:133]
    v_pk_mul_f32 v[28:29], v[132:133], v[132:133]
    v_mov_b64 v[26:27], v[134:135]
    v_pk_mul_f32 v[30:31], v[134:135], v[134:135]
    s_mov_b64 exec, s[40:41]
    v_pk_add_f32 v[16:17], v[16:17], v[144:145]
    v_pk_fma_f32 v[20:21], v[144:145], v[144:145], v[20:21]
    v_pk_add_f32 v[18:19], v[18:19], v[146:147]
    v_pk_fma_f32 v[22:23], v[146:147], v[146:147], v[22:23]
    v_pk_add_f32 v[24:25], v[24:25], v[148:149]
    v_pk_fma_f32 v[28:29], v[148:149], v[148:149], v[28:29]
    v_pk_add_f32 v[26:27], v[26:27], v[150:151]
    v_pk_fma_f32 v[30:31], v[150:151], v[150:151], v[30:31]
    s_mov_b64 exec, s[44:45]
    v_pk_add_f32 v[16:17], v[16:17], v[160:161]
    v_pk_fma_f32 v[20:21], v[160:161], v[160:161], v[20:21]
    v_pk_add_f32 v[18:19], v[18:19], v[162:163]
    v_pk_fma_f32 v[22:23], v[162:163], v[162:163], v[22:23]
    v_pk_add_f32 v[24:25], v[24:25], v[164:165]
    v_pk_fma_f32 v[28:29], v[164:165], v[164:165], v[28:29]
    v_pk_add_f32 v[26:27], v[26:27], v[166:167]
    v_pk_fma_f32 v[30:31], v[166:167], v[166:167], v[30:31]
    v_pk_add_f32 v[16:17], v[16:17], v[176:177]
    v_pk_fma_f32 v[20:21], v[176:177], v[176:177], v[20:21]
    v_pk_add_f32 v[18:19], v[18:19], v[178:179]
    v_pk_fma_f32 v[22:23], v[178:179], v[178:179], v[22:23]
    v_pk_add_f32 v[24:25], v[24:25], v[180:181]
    v_pk_fma_f32 v[28:29], v[180:181], v[180:181], v[28:29]
    v_pk_add_f32 v[26:27], v[26:27], v[182:183]
    v_pk_fma_f32 v[30:31], v[182:183], v[182:183], v[30:31]
    v_pk_add_f32 v[16:17], v[16:17], v[192:193]
    v_pk_fma_f32 v[20:21], v[192:193], v[192:193], v[20:21]
    v_pk_add_f32 v[18:19], v[18:19], v[194:195]
    v_pk_fma_f32 v[22:23], v[194:195], v[194:195], v[22:23]
    v_pk_add_f32 v[24:25], v[24:25], v[196:197]
    v_pk_fma_f32 v[28:29], v[196:197], v[196:197], v[28:29]
    v_pk_add_f32 v[26:27], v[26:27], v[198:199]
    v_pk_fma_f32 v[30:31], v[198:199], v[198:199], v[30:31]
    v_pk_add_f32 v[16:17], v[16:17], v[208:209]
    v_pk_fma_f32 v[20:21], v[208:209], v[208:209], v[20:21]
    v_pk_add_f32 v[18:19], v[18:19], v[210:211]
    v_pk_fma_f32 v[22:23], v[210:211], v[210:211], v[22:23]
    v_pk_add_f32 v[24:25], v[24:25], v[212:213]
    v_pk_fma_f32 v[28:29], v[212:213], v[212:213], v[28:29]
    v_pk_add_f32 v[26:27], v[26:27], v[214:215]
    v_pk_fma_f32 v[30:31], v[214:215], v[214:215], v[30:31]
    v_pk_add_f32 v[16:17], v[16:17], v[224:225]
    v_pk_fma_f32 v[20:21], v[224:225], v[224:225], v[20:21]
    v_pk_add_f32 v[18:19], v[18:19], v[226:227]
    v_pk_fma_f32 v[22:23], v[226:227], v[226:227], v[22:23]
    v_pk_add_f32 v[24:25], v[24:25], v[228:229]
    v_pk_fma_f32 v[28:29], v[228:229], v[228:229], v[28:29]
    v_pk_add_f32 v[26:27], v[26:27], v[230:231]
    v_pk_fma_f32 v[30:31], v[230:231], v[230:231], v[30:31]
    v_pk_add_f32 v[16:17], v[16:17], v[240:241]
    v_pk_fma_f32 v[20:21], v[240:241], v[240:241], v[20:21]
    v_pk_add_f32 v[18:19], v[18:19], v[242:243]
    v_pk_fma_f32 v[22:23], v[242:243], v[242:243], v[22:23]
    v_pk_add_f32 v[24:25], v[24:25], v[244:245]
    v_pk_fma_f32 v[28:29], v[244:245], v[244:245], v[28:29]
    v_pk_add_f32 v[26:27], v[26:27], v[246:247]
    v_pk_fma_f32 v[30:31], v[246:247], v[246:247], v[30:31]
    s_mov_b64 exec, -1
    v_add_f32_dpp v16, v16, v16 row_ror:8 row_mask:0xf bank_mask:0x3
    v_add_f32_dpp v17, v17, v17 row_ror:8 row_mask:0xf bank_mask:0x3
    v_add_f32_dpp v18, v18, v18 row_ror:8 row_mask:0xf bank_mask:0x3
    v_add_f32_dpp v19, v19, v19 row_ror:8 row_mask:0xf bank_mask:0x3
    v_add_f32_dpp v20, v20, v20 row_ror:8 row_mask:0xf bank_mask:0x3
    v_add_f32_dpp v21, v21, v21 row_ror:8 row_mask:0xf bank_mask:0x3
    v_add_f32_dpp v22, v22, v22 row_ror:8 row_mask:0xf bank_mask:0x3
    v_add_f32_dpp v23, v23, v23 row_ror:8 row_mask:0xf bank_mask:0x3
    v_add_f32_dpp v16, v24, v24 row_ror:8 row_mask:0xf bank_mask:0xc
    v_add_f32_dpp v17, v25, v25 row_ror:8 row_mask:0xf bank_mask:0xc
    v_add_f32_dpp v18, v26, v26 row_ror:8 row_mask:0xf bank_mask:0xc
    v_add_f32_dpp v19, v27, v27 row_ror:8 row_mask:0xf bank_mask:0xc
    v_add_f32_dpp v20, v28, v28 row_ror:8 row_mask:0xf bank_mask:0xc
    v_add_f32_dpp v21, v29, v29 row_ror:8 row_mask:0xf bank_mask:0xc
    v_add_f32_dpp v22, v30, v30 row_ror:8 row_mask:0xf bank_mask:0xc
    v_add_f32_dpp v23, v31, v31 row_ror:8 row_mask:0xf bank_mask:0xc
    v_add_f32_dpp v16, v16, v16 row_shl:4 row_mask:0xf bank_mask:0x5
    v_add_f32_dpp v17, v17, v17 row_shl:4 row_mask:0xf bank_mask:0x5
    v_add_f32_dpp v18, v18, v18 row_shl:4 row_mask:0xf bank_mask:0x5
    v_add_f32_dpp v19, v19, v19 row_shl:4 row_mask:0xf bank_mask:0x5
    v_add_f32_dpp v16, v20, v20 row_shr:4 row_mask:0xf bank_mask:0xa
    v_add_f32_dpp v17, v21, v21 row_shr:4 row_mask:0xf bank_mask:0xa
    v_add_f32_dpp v18, v22, v22 row_shr:4 row_mask:0xf bank_mask:0xa
    v_add_f32_dpp v19, v23, v23 row_shr:4 row_mask:0xf bank_mask:0xa
    v_add_f32_dpp v16, v16, v16 quad_perm:[2,3,0,1] row_mask:0xf bank_mask:0xf
    v_add_f32_dpp v17, v17, v17 quad_perm:[2,3,0,1] row_mask:0xf bank_mask:0xf
    v_add_f32_dpp v18, v18, v18 quad_perm:[2,3,0,1] row_mask:0xf bank_mask:0xf
    v_add_f32_dpp v19, v19, v19 quad_perm:[2,3,0,1] row_mask:0xf bank_mask:0xf
    v_add_f32_dpp v16, v16, v16 quad_perm:[1,0,3,2] row_mask:0xf bank_mask:0xf
    v_add_f32_dpp v17, v17, v17 quad_perm:[1,0,3,2] row_mask:0xf bank_mask:0xf
    v_add_f32_dpp v18, v18, v18 quad_perm:[1,0,3,2] row_mask:0xf bank_mask:0xf
    v_add_f32_dpp v19, v19, v19 quad_perm:[1,0,3,2] row_mask:0xf bank_mask:0xf
    v_min_u32 v16, -2, v16
    v_min_u32 v17, -2, v17
    v_min_u32 v18, -2, v18
    v_min_u32 v19, -2, v19
    s_mov_b64 exec, s[42:43]
    buffer_store_dwordx4 v[16:19], v14, s[32:35], 0 offen offset:0 sc1
    s_mov_b64 exec, -1
    s_waitcnt lgkmcnt(15)
    v_mfma_f32_16x16x32_bf16 v[136:139], v[80:83], v[40:43], v[136:139]
    ds_read_b128 v[32:35], v6 offset:0
    v_mfma_f32_16x16x32_bf16 v[136:139], v[84:87], v[44:47], v[136:139]
    ds_read_b128 v[36:39], v7 offset:0
    v_mfma_f32_16x16x32_bf16 v[140:143], v[88:91], v[40:43], v[140:143]
    v_mfma_f32_16x16x32_bf16 v[140:143], v[92:95], v[44:47], v[140:143]
    s_waitcnt lgkmcnt(15)
    v_mfma_f32_16x16x32_bf16 v[140:143], v[104:107], v[48:51], v[140:143]
    ds_read_b128 v[40:43], v8 offset:2048
    v_mfma_f32_16x16x32_bf16 v[140:143], v[108:111], v[52:55], v[140:143]
    ds_read_b128 v[44:47], v9 offset:2048
    v_mfma_f32_16x16x32_bf16 v[136:139], v[96:99], v[48:51], v[136:139]
    v_mfma_f32_16x16x32_bf16 v[136:139], v[100:103], v[52:55], v[136:139]
    s_waitcnt lgkmcnt(12)
    v_mfma_f32_16x16x32_bf16 v[136:139], v[112:115], v[56:59], v[136:139]
    ds_read_b128 v[48:51], v2 offset:2048
    v_mfma_f32_16x16x32_bf16 v[136:139], v[116:119], v[60:63], v[136:139]
    ds_read_b128 v[52:55], v2 offset:4096
    v_mfma_f32_16x16x32_bf16 v[140:143], v[120:123], v[56:59], v[140:143]
    v_mfma_f32_16x16x32_bf16 v[140:143], v[124:127], v[60:63], v[140:143]
    s_waitcnt lgkmcnt(4)
    v_mfma_f32_16x16x32_bf16 v[140:143], v[72:75], v[32:35], v[140:143]
    ds_read_b128 v[56:59], v15 offset:2048
    v_mfma_f32_16x16x32_bf16 v[140:143], v[76:79], v[36:39], v[140:143]
    ds_read_b128 v[60:63], v15 offset:4096
    v_mfma_f32_16x16x32_bf16 v[136:139], v[64:67], v[32:35], v[136:139]
    v_mfma_f32_16x16x32_bf16 v[136:139], v[68:71], v[36:39], v[136:139]
    s_waitcnt lgkmcnt(4)
    v_mfma_f32_16x16x32_bf16 v[152:155], v[80:83], v[40:43], v[152:155]
    ds_read_b128 v[32:35], v6 offset:2048
    v_mfma_f32_16x16x32_bf16 v[152:155], v[84:87], v[44:47], v[152:155]
    ds_read_b128 v[36:39], v7 offset:2048
    v_mfma_f32_16x16x32_bf16 v[156:159], v[88:91], v[40:43], v[156:159]
    v_mfma_f32_16x16x32_bf16 v[156:159], v[92:95], v[44:47], v[156:159]
    s_waitcnt lgkmcnt(4)
    v_mfma_f32_16x16x32_bf16 v[156:159], v[104:107], v[48:51], v[156:159]
    ds_read_b128 v[40:43], v8 offset:4096
    v_mov_b32 v16, v136
    v_mfma_f32_16x16x32_bf16 v[156:159], v[108:111], v[52:55], v[156:159]
    ds_read_b128 v[44:47], v9 offset:4096
    v_mul_f32 v20, v136, v136
    v_mfma_f32_16x16x32_bf16 v[152:155], v[96:99], v[48:51], v[152:155]
    v_mov_b32 v17, v137
    v_mul_f32 v21, v137, v137
    v_mfma_f32_16x16x32_bf16 v[152:155], v[100:103], v[52:55], v[152:155]
    v_mov_b32 v18, v138
    s_waitcnt lgkmcnt(4)
    v_mfma_f32_16x16x32_bf16 v[152:155], v[112:115], v[56:59], v[152:155]
    ds_read_b128 v[48:51], v2 offset:4096
    v_mul_f32 v22, v138, v138
    v_mfma_f32_16x16x32_bf16 v[152:155], v[116:119], v[60:63], v[152:155]
    ds_read_b128 v[52:55], v2 offset:6144
    v_mov_b32 v19, v139
    v_mfma_f32_16x16x32_bf16 v[156:159], v[120:123], v[56:59], v[156:159]
    v_mul_f32 v23, v139, v139
    v_mov_b32 v24, v140
    v_mfma_f32_16x16x32_bf16 v[156:159], v[124:127], v[60:63], v[156:159]
    v_mul_f32 v28, v140, v140
    s_waitcnt lgkmcnt(4)
    v_mfma_f32_16x16x32_bf16 v[156:159], v[72:75], v[32:35], v[156:159]
    ds_read_b128 v[56:59], v15 offset:4096
    v_mov_b32 v25, v141
    v_mfma_f32_16x16x32_bf16 v[156:159], v[76:79], v[36:39], v[156:159]
    ds_read_b128 v[60:63], v15 offset:6144
    v_mul_f32 v29, v141, v141
    v_mfma_f32_16x16x32_bf16 v[152:155], v[64:67], v[32:35], v[152:155]
    s_barrier
    v_mov_b32 v26, v142
    v_mfma_f32_16x16x32_bf16 v[152:155], v[68:71], v[36:39], v[152:155]
    v_mul_f32 v30, v142, v142
    s_waitcnt lgkmcnt(4)
    v_mfma_f32_16x16x32_bf16 v[168:171], v[80:83], v[40:43], v[168:171]
    ds_read_b128 v[32:35], v6 offset:4096
    v_mov_b32 v27, v143
    v_mfma_f32_16x16x32_bf16 v[168:171], v[84:87], v[44:47], v[168:171]
    ds_read_b128 v[36:39], v7 offset:4096
    v_mul_f32 v31, v143, v143
    v_mfma_f32_16x16x32_bf16 v[172:175], v[88:91], v[40:43], v[172:175]
    s_mov_b64 exec, s[40:41]
    v_add_f32 v16, v16, v152
    v_mfma_f32_16x16x32_bf16 v[172:175], v[92:95], v[44:47], v[172:175]
    v_fmac_f32 v20, v152, v152
    s_waitcnt lgkmcnt(4)
    v_mfma_f32_16x16x32_bf16 v[172:175], v[104:107], v[48:51], v[172:175]
    ds_read_b128 v[40:43], v8 offset:6144
    v_add_f32 v17, v17, v153
    v_mfma_f32_16x16x32_bf16 v[172:175], v[108:111], v[52:55], v[172:175]
    ds_read_b128 v[44:47], v9 offset:6144
    v_fmac_f32 v21, v153, v153
    v_mfma_f32_16x16x32_bf16 v[168:171], v[96:99], v[48:51], v[168:171]
    v_add_f32 v18, v18, v154
    v_fmac_f32 v22, v154, v154
    v_mfma_f32_16x16x32_bf16 v[168:171], v[100:103], v[52:55], v[168:171]
    v_add_f32 v19, v19, v155
    s_waitcnt lgkmcnt(4)
    v_mfma_f32_16x16x32_bf16 v[168:171], v[112:115], v[56:59], v[168:171]
    ds_read_b128 v[48:51], v2 offset:6144
    v_fmac_f32 v23, v155, v155
    v_mfma_f32_16x16x32_bf16 v[168:171], v[116:119], v[60:63], v[168:171]
    ds_read_b128 v[52:55], v2 offset:8192
    v_add_f32 v24, v24, v156
    v_mfma_f32_16x16x32_bf16 v[172:175], v[120:123], v[56:59], v[172:175]
    v_fmac_f32 v28, v156, v156
    v_add_f32 v25, v25, v157
    v_mfma_f32_16x16x32_bf16 v[172:175], v[124:127], v[60:63], v[172:175]
    v_fmac_f32 v29, v157, v157
    s_waitcnt lgkmcnt(4)
    v_mfma_f32_16x16x32_bf16 v[172:175], v[72:75], v[32:35], v[172:175]
    ds_read_b128 v[56:59], v15 offset:6144
    v_add_f32 v26, v26, v158
    v_mfma_f32_16x16x32_bf16 v[172:175], v[76:79], v[36:39], v[172:175]
    ds_read_b128 v[60:63], v15 offset:8192
    v_fmac_f32 v30, v158, v158
    v_mfma_f32_16x16x32_bf16 v[168:171], v[64:67], v[32:35], v[168:171]
    v_add_f32 v27, v27, v159
    v_fmac_f32 v31, v159, v159
    v_mfma_f32_16x16x32_bf16 v[168:171], v[68:71], v[36:39], v[168:171]
    s_waitcnt lgkmcnt(4)
    v_mfma_f32_16x16x32_bf16 v[184:187], v[80:83], v[40:43], v[184:187]
    ds_read_b128 v[32:35], v6 offset:6144
    s_mov_b64 exec, s[44:45]
    v_mfma_f32_16x16x32_bf16 v[184:187], v[84:87], v[44:47], v[184:187]
    ds_read_b128 v[36:39], v7 offset:6144
    v_mfma_f32_16x16x32_bf16 v[188:191], v[88:91], v[40:43], v[188:191]
    v_mfma_f32_16x16x32_bf16 v[188:191], v[92:95], v[44:47], v[188:191]
    v_add_f32 v16, v16, v168
    s_waitcnt lgkmcnt(4)
    v_mfma_f32_16x16x32_bf16 v[188:191], v[104:107], v[48:51], v[188:191]
    ds_read_b128 v[40:43], v8 offset:8192
    v_fmac_f32 v20, v168, v168
    v_mfma_f32_16x16x32_bf16 v[188:191], v[108:111], v[52:55], v[188:191]
    ds_read_b128 v[44:47], v9 offset:8192
    v_add_f32 v17, v17, v169
    v_mfma_f32_16x16x32_bf16 v[184:187], v[96:99], v[48:51], v[184:187]
    v_fmac_f32 v21, v169, v169
    v_add_f32 v18, v18, v170
    v_mfma_f32_16x16x32_bf16 v[184:187], v[100:103], v[52:55], v[184:187]
    v_fmac_f32 v22, v170, v170
    s_waitcnt lgkmcnt(4)
    v_mfma_f32_16x16x32_bf16 v[184:187], v[112:115], v[56:59], v[184:187]
    ds_read_b128 v[48:51], v2 offset:8192
    v_add_f32 v19, v19, v171
    v_mfma_f32_16x16x32_bf16 v[184:187], v[116:119], v[60:63], v[184:187]
    ds_read_b128 v[52:55], v2 offset:10240
    v_fmac_f32 v23, v171, v171
    v_mfma_f32_16x16x32_bf16 v[188:191], v[120:123], v[56:59], v[188:191]
    v_add_f32 v24, v24, v172
    v_fmac_f32 v28, v172, v172
    v_mfma_f32_16x16x32_bf16 v[188:191], v[124:127], v[60:63], v[188:191]
    v_add_f32 v25, v25, v173
    s_waitcnt lgkmcnt(4)
    v_mfma_f32_16x16x32_bf16 v[188:191], v[72:75], v[32:35], v[188:191]
    ds_read_b128 v[56:59], v15 offset:8192
    v_fmac_f32 v29, v173, v173
    v_mfma_f32_16x16x32_bf16 v[188:191], v[76:79], v[36:39], v[188:191]
    ds_read_b128 v[60:63], v15 offset:10240
    v_add_f32 v26, v26, v174
    v_mfma_f32_16x16x32_bf16 v[184:187], v[64:67], v[32:35], v[184:187]
    v_fmac_f32 v30, v174, v174
    v_add_f32 v27, v27, v175
    v_mfma_f32_16x16x32_bf16 v[184:187], v[68:71], v[36:39], v[184:187]
    v_fmac_f32 v31, v175, v175
    s_waitcnt lgkmcnt(4)
    v_mfma_f32_16x16x32_bf16 v[200:203], v[80:83], v[40:43], v[200:203]
    ds_read_b128 v[32:35], v6 offset:8192
    v_mfma_f32_16x16x32_bf16 v[200:203], v[84:87], v[44:47], v[200:203]
    ds_read_b128 v[36:39], v7 offset:8192
    v_mfma_f32_16x16x32_bf16 v[204:207], v[88:91], v[40:43], v[204:207]
    v_mfma_f32_16x16x32_bf16 v[204:207], v[92:95], v[44:47], v[204:207]
    v_add_f32 v16, v16, v184
    s_waitcnt lgkmcnt(4)
    v_mfma_f32_16x16x32_bf16 v[204:207], v[104:107], v[48:51], v[204:207]
    ds_read_b128 v[40:43], v8 offset:10240
    v_fmac_f32 v20, v184, v184
    v_mfma_f32_16x16x32_bf16 v[204:207], v[108:111], v[52:55], v[204:207]
    ds_read_b128 v[44:47], v9 offset:10240
    v_add_f32 v17, v17, v185
    v_mfma_f32_16x16x32_bf16 v[200:203], v[96:99], v[48:51], v[200:203]
    v_fmac_f32 v21, v185, v185
    v_add_f32 v18, v18, v186
    v_mfma_f32_16x16x32_bf16 v[200:203], v[100:103], v[52:55], v[200:203]
    v_fmac_f32 v22, v186, v186
    s_waitcnt lgkmcnt(4)
    v_mfma_f32_16x16x32_bf16 v[200:203], v[112:115], v[56:59], v[200:203]
    ds_read_b128 v[48:51], v2 offset:10240
    v_add_f32 v19, v19, v187
    v_mfma_f32_16x16x32_bf16 v[200:203], v[116:119], v[60:63], v[200:203]
    ds_read_b128 v[52:55], v2 offset:12288
    v_fmac_f32 v23, v187, v187
    v_mfma_f32_16x16x32_bf16 v[204:207], v[120:123], v[56:59], v[204:207]
    v_add_f32 v24, v24, v188
    v_fmac_f32 v28, v188, v188
    v_mfma_f32_16x16x32_bf16 v[204:207], v[124:127], v[60:63], v[204:207]
    v_add_f32 v25, v25, v189
    s_waitcnt lgkmcnt(4)
    v_mfma_f32_16x16x32_bf16 v[204:207], v[72:75], v[32:35], v[204:207]
    ds_read_b128 v[56:59], v15 offset:10240
    v_fmac_f32 v29, v189, v189
    v_mfma_f32_16x16x32_bf16 v[204:207], v[76:79], v[36:39], v[204:207]
    ds_read_b128 v[60:63], v15 offset:12288
    v_add_f32 v26, v26, v190
    v_mfma_f32_16x16x32_bf16 v[200:203], v[64:67], v[32:35], v[200:203]
    v_fmac_f32 v30, v190, v190
    v_add_f32 v27, v27, v191
    v_mfma_f32_16x16x32_bf16 v[200:203], v[68:71], v[36:39], v[200:203]
    v_fmac_f32 v31, v191, v191
    s_waitcnt lgkmcnt(4)
    v_mfma_f32_16x16x32_bf16 v[216:219], v[80:83], v[40:43], v[216:219]
    ds_read_b128 v[32:35], v6 offset:10240
    v_mfma_f32_16x16x32_bf16 v[216:219], v[84:87], v[44:47], v[216:219]
    ds_read_b128 v[36:39], v7 offset:10240
    v_mfma_f32_16x16x32_bf16 v[220:223], v[88:91], v[40:43], v[220:223]
    v_mfma_f32_16x16x32_bf16 v[220:223], v[92:95], v[44:47], v[220:223]
    v_add_f32 v16, v16, v200
    s_waitcnt lgkmcnt(4)
    v_mfma_f32_16x16x32_bf16 v[220:223], v[104:107], v[48:51], v[220:223]
    ds_read_b128 v[40:43], v8 offset:12288
    v_fmac_f32 v20, v200, v200
    v_mfma_f32_16x16x32_bf16 v[220:223], v[108:111], v[52:55], v[220:223]
    ds_read_b128 v[44:47], v9 offset:12288
    v_add_f32 v17, v17, v201
    v_mfma_f32_16x16x32_bf16 v[216:219], v[96:99], v[48:51], v[216:219]
    v_fmac_f32 v21, v201, v201
    v_add_f32 v18, v18, v202
    v_mfma_f32_16x16x32_bf16 v[216:219], v[100:103], v[52:55], v[216:219]
    v_fmac_f32 v22, v202, v202
    s_waitcnt lgkmcnt(4)
    v_mfma_f32_16x16x32_bf16 v[216:219], v[112:115], v[56:59], v[216:219]
    ds_read_b128 v[48:51], v2 offset:12288
    v_add_f32 v19, v19, v203
    v_mfma_f32_16x16x32_bf16 v[216:219], v[116:119], v[60:63], v[216:219]
    ds_read_b128 v[52:55], v2 offset:14336
    v_fmac_f32 v23, v203, v203
    v_mfma_f32_16x16x32_bf16 v[220:223], v[120:123], v[56:59], v[220:223]
    v_add_f32 v24, v24, v204
    v_fmac_f32 v28, v204, v204
    v_mfma_f32_16x16x32_bf16 v[220:223], v[124:127], v[60:63], v[220:223]
    v_add_f32 v25, v25, v205
    s_waitcnt lgkmcnt(4)
    v_mfma_f32_16x16x32_bf16 v[220:223], v[72:75], v[32:35], v[220:223]
    ds_read_b128 v[56:59], v15 offset:12288
    v_fmac_f32 v29, v205, v205
    v_mfma_f32_16x16x32_bf16 v[220:223], v[76:79], v[36:39], v[220:223]
    ds_read_b128 v[60:63], v15 offset:14336
    v_add_f32 v26, v26, v206
    v_mfma_f32_16x16x32_bf16 v[216:219], v[64:67], v[32:35], v[216:219]
    v_fmac_f32 v30, v206, v206
    v_add_f32 v27, v27, v207
    v_mfma_f32_16x16x32_bf16 v[216:219], v[68:71], v[36:39], v[216:219]
    v_fmac_f32 v31, v207, v207
    s_waitcnt lgkmcnt(4)
    v_mfma_f32_16x16x32_bf16 v[232:235], v[80:83], v[40:43], v[232:235]
    ds_read_b128 v[32:35], v6 offset:12288
    v_mfma_f32_16x16x32_bf16 v[232:235], v[84:87], v[44:47], v[232:235]
    ds_read_b128 v[36:39], v7 offset:12288
    v_mfma_f32_16x16x32_bf16 v[236:239], v[88:91], v[40:43], v[236:239]
    v_mfma_f32_16x16x32_bf16 v[236:239], v[92:95], v[44:47], v[236:239]
    v_add_f32 v16, v16, v216
    s_waitcnt lgkmcnt(4)
    v_mfma_f32_16x16x32_bf16 v[236:239], v[104:107], v[48:51], v[236:239]
    ds_read_b128 v[40:43], v8 offset:14336
    v_fmac_f32 v20, v216, v216
    v_mfma_f32_16x16x32_bf16 v[236:239], v[108:111], v[52:55], v[236:239]
    ds_read_b128 v[44:47], v9 offset:14336
    v_add_f32 v17, v17, v217
    v_mfma_f32_16x16x32_bf16 v[232:235], v[96:99], v[48:51], v[232:235]
    v_fmac_f32 v21, v217, v217
    v_add_f32 v18, v18, v218
    v_mfma_f32_16x16x32_bf16 v[232:235], v[100:103], v[52:55], v[232:235]
    v_fmac_f32 v22, v218, v218
    s_waitcnt lgkmcnt(4)
    v_mfma_f32_16x16x32_bf16 v[232:235], v[112:115], v[56:59], v[232:235]
    ds_read_b128 v[48:51], v2 offset:14336
    v_add_f32 v19, v19, v219
    v_mfma_f32_16x16x32_bf16 v[232:235], v[116:119], v[60:63], v[232:235]
    ds_read_b128 v[52:55], v3 offset:0
    v_fmac_f32 v23, v219, v219
    v_mfma_f32_16x16x32_bf16 v[236:239], v[120:123], v[56:59], v[236:239]
    v_add_f32 v24, v24, v220
    v_fmac_f32 v28, v220, v220
    v_mfma_f32_16x16x32_bf16 v[236:239], v[124:127], v[60:63], v[236:239]
    v_add_f32 v25, v25, v221
    s_waitcnt lgkmcnt(4)
    v_mfma_f32_16x16x32_bf16 v[236:239], v[72:75], v[32:35], v[236:239]
    ds_read_b128 v[56:59], v15 offset:14336
    v_fmac_f32 v29, v221, v221
    v_mfma_f32_16x16x32_bf16 v[236:239], v[76:79], v[36:39], v[236:239]
    ds_read_b128 v[60:63], v11 offset:0
    v_add_f32 v26, v26, v222
    v_mfma_f32_16x16x32_bf16 v[232:235], v[64:67], v[32:35], v[232:235]
    v_fmac_f32 v30, v222, v222
    v_add_f32 v27, v27, v223
    v_mfma_f32_16x16x32_bf16 v[232:235], v[68:71], v[36:39], v[232:235]
    v_fmac_f32 v31, v223, v223
    s_waitcnt lgkmcnt(4)
    v_mfma_f32_16x16x32_bf16 v[248:251], v[80:83], v[40:43], v[248:251]
    ds_read_b128 v[32:35], v6 offset:14336
    v_mfma_f32_16x16x32_bf16 v[248:251], v[84:87], v[44:47], v[248:251]
    ds_read_b128 v[36:39], v7 offset:14336
    v_mfma_f32_16x16x32_bf16 v[252:255], v[88:91], v[40:43], v[252:255]
    v_mfma_f32_16x16x32_bf16 v[252:255], v[92:95], v[44:47], v[252:255]
    v_add_f32 v16, v16, v232
    s_waitcnt lgkmcnt(4)
    v_mfma_f32_16x16x32_bf16 v[252:255], v[104:107], v[48:51], v[252:255]
    v_fmac_f32 v20, v232, v232
    v_add_f32 v17, v17, v233
    v_mfma_f32_16x16x32_bf16 v[252:255], v[108:111], v[52:55], v[252:255]
    v_fmac_f32 v21, v233, v233
    v_add_f32 v18, v18, v234
    v_mfma_f32_16x16x32_bf16 v[248:251], v[96:99], v[48:51], v[248:251]
    v_fmac_f32 v22, v234, v234
    v_add_f32 v19, v19, v235
    v_mfma_f32_16x16x32_bf16 v[248:251], v[100:103], v[52:55], v[248:251]
    v_fmac_f32 v23, v235, v235
    s_waitcnt lgkmcnt(2)
    v_mfma_f32_16x16x32_bf16 v[248:251], v[112:115], v[56:59], v[248:251]
    v_add_f32 v24, v24, v236
    v_fmac_f32 v28, v236, v236
    v_mfma_f32_16x16x32_bf16 v[248:251], v[116:119], v[60:63], v[248:251]
    v_add_f32 v25, v25, v237
    v_fmac_f32 v29, v237, v237
    v_mfma_f32_16x16x32_bf16 v[252:255], v[120:123], v[56:59], v[252:255]
    v_add_f32 v26, v26, v238
    v_fmac_f32 v30, v238, v238
    v_mfma_f32_16x16x32_bf16 v[252:255], v[124:127], v[60:63], v[252:255]
    v_add_f32 v27, v27, v239
    s_waitcnt lgkmcnt(0)
    v_mfma_f32_16x16x32_bf16 v[252:255], v[72:75], v[32:35], v[252:255]
    v_fmac_f32 v31, v239, v239
    v_mfma_f32_16x16x32_bf16 v[252:255], v[76:79], v[36:39], v[252:255]
    v_mfma_f32_16x16x32_bf16 v[248:251], v[64:67], v[32:35], v[248:251]
    v_mfma_f32_16x16x32_bf16 v[248:251], v[68:71], v[36:39], v[248:251]
    s_nop 7
    v_pk_add_f32 v[16:17], v[16:17], v[248:249]
    v_pk_fma_f32 v[20:21], v[248:249], v[248:249], v[20:21]
    v_pk_add_f32 v[18:19], v[18:19], v[250:251]
    v_pk_fma_f32 v[22:23], v[250:251], v[250:251], v[22:23]
    v_pk_add_f32 v[24:25], v[24:25], v[252:253]
    v_pk_fma_f32 v[28:29], v[252:253], v[252:253], v[28:29]
    v_pk_add_f32 v[26:27], v[26:27], v[254:255]
    v_pk_fma_f32 v[30:31], v[254:255], v[254:255], v[30:31]
    s_mov_b64 exec, -1
    v_add_f32_dpp v16, v16, v16 row_ror:8 row_mask:0xf bank_mask:0x3
    v_add_f32_dpp v17, v17, v17 row_ror:8 row_mask:0xf bank_mask:0x3
    v_add_f32_dpp v18, v18, v18 row_ror:8 row_mask:0xf bank_mask:0x3
    v_add_f32_dpp v19, v19, v19 row_ror:8 row_mask:0xf bank_mask:0x3
    v_add_f32_dpp v20, v20, v20 row_ror:8 row_mask:0xf bank_mask:0x3
    v_add_f32_dpp v21, v21, v21 row_ror:8 row_mask:0xf bank_mask:0x3
    v_add_f32_dpp v22, v22, v22 row_ror:8 row_mask:0xf bank_mask:0x3
    v_add_f32_dpp v23, v23, v23 row_ror:8 row_mask:0xf bank_mask:0x3
    v_add_f32_dpp v16, v24, v24 row_ror:8 row_mask:0xf bank_mask:0xc
    v_add_f32_dpp v17, v25, v25 row_ror:8 row_mask:0xf bank_mask:0xc
    v_add_f32_dpp v18, v26, v26 row_ror:8 row_mask:0xf bank_mask:0xc
    v_add_f32_dpp v19, v27, v27 row_ror:8 row_mask:0xf bank_mask:0xc
    v_add_f32_dpp v20, v28, v28 row_ror:8 row_mask:0xf bank_mask:0xc
    v_add_f32_dpp v21, v29, v29 row_ror:8 row_mask:0xf bank_mask:0xc
    v_add_f32_dpp v22, v30, v30 row_ror:8 row_mask:0xf bank_mask:0xc
    v_add_f32_dpp v23, v31, v31 row_ror:8 row_mask:0xf bank_mask:0xc
    v_add_f32_dpp v16, v16, v16 row_shl:4 row_mask:0xf bank_mask:0x5
    v_add_f32_dpp v17, v17, v17 row_shl:4 row_mask:0xf bank_mask:0x5
    v_add_f32_dpp v18, v18, v18 row_shl:4 row_mask:0xf bank_mask:0x5
    v_add_f32_dpp v19, v19, v19 row_shl:4 row_mask:0xf bank_mask:0x5
    v_add_f32_dpp v16, v20, v20 row_shr:4 row_mask:0xf bank_mask:0xa
    v_add_f32_dpp v17, v21, v21 row_shr:4 row_mask:0xf bank_mask:0xa
    v_add_f32_dpp v18, v22, v22 row_shr:4 row_mask:0xf bank_mask:0xa
    v_add_f32_dpp v19, v23, v23 row_shr:4 row_mask:0xf bank_mask:0xa
    v_add_f32_dpp v16, v16, v16 quad_perm:[2,3,0,1] row_mask:0xf bank_mask:0xf
    v_add_f32_dpp v17, v17, v17 quad_perm:[2,3,0,1] row_mask:0xf bank_mask:0xf
    v_add_f32_dpp v18, v18, v18 quad_perm:[2,3,0,1] row_mask:0xf bank_mask:0xf
    v_add_f32_dpp v19, v19, v19 quad_perm:[2,3,0,1] row_mask:0xf bank_mask:0xf
    v_add_f32_dpp v16, v16, v16 quad_perm:[1,0,3,2] row_mask:0xf bank_mask:0xf
    v_add_f32_dpp v17, v17, v17 quad_perm:[1,0,3,2] row_mask:0xf bank_mask:0xf
    v_add_f32_dpp v18, v18, v18 quad_perm:[1,0,3,2] row_mask:0xf bank_mask:0xf
    v_add_f32_dpp v19, v19, v19 quad_perm:[1,0,3,2] row_mask:0xf bank_mask:0xf
    v_min_u32 v16, -2, v16
    v_min_u32 v17, -2, v17
    v_min_u32 v18, -2, v18
    v_min_u32 v19, -2, v19
    s_mov_b64 exec, s[42:43]
    buffer_store_dwordx4 v[16:19], v14, s[32:35], s62 offen offset:0 sc1
    s_mov_b64 exec, -1
    s_setprio 0
    s_cmp_lg_u32 0, 0
    s_barrier
    ds_read_b128 v[96:99], v5 offset:0
    ds_read_b128 v[100:103], v5 offset:4096
    ds_read_b128 v[104:107], v5 offset:64
    ds_read_b128 v[108:111], v5 offset:4160
    s_branch L_epi
L_epi2:
    s_barrier
    ds_read_b128 v[96:99], v5 offset:32768
    ds_read_b128 v[100:103], v5 offset:36864
    ds_read_b128 v[104:107], v5 offset:32832
    ds_read_b128 v[108:111], v5 offset:36928
    v_mov_b64 v[128:129], v[136:137]
    v_mov_b64 v[130:131], v[138:139]
    v_mov_b64 v[132:133], v[140:141]
    v_mov_b64 v[134:135], v[142:143]
    v_mov_b64 v[144:145], v[152:153]
    v_mov_b64 v[146:147], v[154:155]
    v_mov_b64 v[148:149], v[156:157]
    v_mov_b64 v[150:151], v[158:159]
    v_mov_b64 v[160:161], v[168:169]
    v_mov_b64 v[162:163], v[170:171]
    v_mov_b64 v[164:165], v[172:173]
    v_mov_b64 v[166:167], v[174:175]
    v_mov_b64 v[176:177], v[184:185]
    v_mov_b64 v[178:179], v[186:187]
    v_mov_b64 v[180:181], v[188:189]
    v_mov_b64 v[182:183], v[190:191]
    v_mov_b64 v[192:193], v[200:201]
    v_mov_b64 v[194:195], v[202:203]
    v_mov_b64 v[196:197], v[204:205]
    v_mov_b64 v[198:199], v[206:207]
    v_mov_b64 v[208:209], v[216:217]
    v_mov_b64 v[210:211], v[218:219]
    v_mov_b64 v[212:213], v[220:221]
    v_mov_b64 v[214:215], v[222:223]
    v_mov_b64 v[224:225], v[232:233]
    v_mov_b64 v[226:227], v[234:235]
    v_mov_b64 v[228:229], v[236:237]
    v_mov_b64 v[230:231], v[238:239]
    v_mov_b64 v[240:241], v[248:249]
    v_mov_b64 v[242:243], v[250:251]
    v_mov_b64 v[244:245], v[252:253]
    v_mov_b64 v[246:247], v[254:255]
    v_xor_b32 v1, 64, v1
    s_cmp_eq_u32 0, 0
L_epi:
    s_waitcnt lgkmcnt(0)
    v_pk_fma_f32 v[128:129], v[128:129], v[96:97], v[100:101]
    v_pk_fma_f32 v[130:131], v[130:131], v[98:99], v[102:103]
    v_pk_fma_f32 v[132:133], v[132:133], v[104:105], v[108:109]
    v_pk_fma_f32 v[134:135], v[134:135], v[106:107], v[110:111]
    v_pk_fma_f32 v[32:33], v[128:129], v[128:129], s[46:47] op_sel_hi:[1,1,0]
    v_pk_fma_f32 v[34:35], v[130:131], v[130:131], s[46:47] op_sel_hi:[1,1,0]
    v_pk_fma_f32 v[36:37], v[132:133], v[132:133], s[46:47] op_sel_hi:[1,1,0]
    v_pk_fma_f32 v[38:39], v[134:135], v[134:135], s[46:47] op_sel_hi:[1,1,0]
    v_pk_mul_f32 v[32:33], v[32:33], v[128:129] neg_lo:[1,0] neg_hi:[1,0]
    v_pk_mul_f32 v[34:35], v[34:35], v[130:131] neg_lo:[1,0] neg_hi:[1,0]
    v_pk_mul_f32 v[36:37], v[36:37], v[132:133] neg_lo:[1,0] neg_hi:[1,0]
    v_pk_mul_f32 v[38:39], v[38:39], v[134:135] neg_lo:[1,0] neg_hi:[1,0]
    v_exp_f32 v32, v32
    v_exp_f32 v33, v33
    v_exp_f32 v34, v34
    v_exp_f32 v35, v35
    v_exp_f32 v36, v36
    v_exp_f32 v37, v37
    v_exp_f32 v38, v38
    v_exp_f32 v39, v39
    v_pk_fma_f32 v[32:33], v[32:33], s[46:47], s[46:47] op_sel:[0,1,1] op_sel_hi:[1,1,1]
    v_pk_fma_f32 v[34:35], v[34:35], s[46:47], s[46:47] op_sel:[0,1,1] op_sel_hi:[1,1,1]
    v_pk_fma_f32 v[36:37], v[36:37], s[46:47], s[46:47] op_sel:[0,1,1] op_sel_hi:[1,1,1]
    v_pk_fma_f32 v[38:39], v[38:39], s[46:47], s[46:47] op_sel:[0,1,1] op_sel_hi:[1,1,1]
    v_rcp_f32 v32, v32
    v_rcp_f32 v33, v33
    v_rcp_f32 v34, v34
    v_rcp_f32 v35, v35
    v_rcp_f32 v36, v36
    v_rcp_f32 v37, v37
    v_rcp_f32 v38, v38
    v_rcp_f32 v39, v39
    v_pk_mul_f32 v[32:33], v[32:33], v[128:129]
    v_pk_mul_f32 v[34:35], v[34:35], v[130:131]
    v_pk_mul_f32 v[36:37], v[36:37], v[132:133]
    v_pk_mul_f32 v[38:39], v[38:39], v[134:135]
    v_cvt_pk_bf16_f32 v64, v32, v33
    v_cvt_pk_bf16_f32 v65, v34, v35
    v_cvt_pk_bf16_f32 v66, v36, v37
    v_cvt_pk_bf16_f32 v67, v38, v39
    buffer_store_dwordx4 v[64:67], v1, s[28:31], 0 offen offset:0 sc1
    v_pk_fma_f32 v[144:145], v[144:145], v[96:97], v[100:101]
    v_pk_fma_f32 v[146:147], v[146:147], v[98:99], v[102:103]
    v_pk_fma_f32 v[148:149], v[148:149], v[104:105], v[108:109]
    v_pk_fma_f32 v[150:151], v[150:151], v[106:107], v[110:111]
    v_pk_fma_f32 v[40:41], v[144:145], v[144:145], s[46:47] op_sel_hi:[1,1,0]
    v_pk_fma_f32 v[42:43], v[146:147], v[146:147], s[46:47] op_sel_hi:[1,1,0]
    v_pk_fma_f32 v[44:45], v[148:149], v[148:149], s[46:47] op_sel_hi:[1,1,0]
    v_pk_fma_f32 v[46:47], v[150:151], v[150:151], s[46:47] op_sel_hi:[1,1,0]
    v_pk_mul_f32 v[40:41], v[40:41], v[144:145] neg_lo:[1,0] neg_hi:[1,0]
    v_pk_mul_f32 v[42:43], v[42:43], v[146:147] neg_lo:[1,0] neg_hi:[1,0]
    v_pk_mul_f32 v[44:45], v[44:45], v[148:149] neg_lo:[1,0] neg_hi:[1,0]
    v_pk_mul_f32 v[46:47], v[46:47], v[150:151] neg_lo:[1,0] neg_hi:[1,0]
    v_exp_f32 v40, v40
    v_exp_f32 v41, v41
    v_exp_f32 v42, v42
    v_exp_f32 v43, v43
    v_exp_f32 v44, v44
    v_exp_f32 v45, v45
    v_exp_f32 v46, v46
    v_exp_f32 v47, v47
    v_pk_fma_f32 v[40:41], v[40:41], s[46:47], s[46:47] op_sel:[0,1,1] op_sel_hi:[1,1,1]
    v_pk_fma_f32 v[42:43], v[42:43], s[46:47], s[46:47] op_sel:[0,1,1] op_sel_hi:[1,1,1]
    v_pk_fma_f32 v[44:45], v[44:45], s[46:47], s[46:47] op_sel:[0,1,1] op_sel_hi:[1,1,1]
    v_pk_fma_f32 v[46:47], v[46:47], s[46:47], s[46:47] op_sel:[0,1,1] op_sel_hi:[1,1,1]
    v_rcp_f32 v40, v40
    v_rcp_f32 v41, v41
    v_rcp_f32 v42, v42
    v_rcp_f32 v43, v43
    v_rcp_f32 v44, v44
    v_rcp_f32 v45, v45
    v_rcp_f32 v46, v46
    v_rcp_f32 v47, v47
    v_pk_mul_f32 v[40:41], v[40:41], v[144:145]
    v_pk_mul_f32 v[42:43], v[42:43], v[146:147]
    v_pk_mul_f32 v[44:45], v[44:45], v[148:149]
    v_pk_mul_f32 v[46:47], v[46:47], v[150:151]
    v_cvt_pk_bf16_f32 v68, v40, v41
    v_cvt_pk_bf16_f32 v69, v42, v43
    v_cvt_pk_bf16_f32 v70, v44, v45
    v_cvt_pk_bf16_f32 v71, v46, v47
    buffer_store_dwordx4 v[68:71], v1, s[28:31], 0 offen offset:1024 sc1
    s_cbranch_scc1 L_nox1b
    s_barrier
L_nox1b:
    v_pk_fma_f32 v[160:161], v[160:161], v[96:97], v[100:101]
    v_pk_fma_f32 v[162:163], v[162:163], v[98:99], v[102:103]
    v_pk_fma_f32 v[164:165], v[164:165], v[104:105], v[108:109]
    v_pk_fma_f32 v[166:167], v[166:167], v[106:107], v[110:111]
    v_pk_fma_f32 v[48:49], v[160:161], v[160:161], s[46:47] op_sel_hi:[1,1,0]
    v_pk_fma_f32 v[50:51], v[162:163], v[162:163], s[46:47] op_sel_hi:[1,1,0]
    v_pk_fma_f32 v[52:53], v[164:165], v[164:165], s[46:47] op_sel_hi:[1,1,0]
    v_pk_fma_f32 v[54:55], v[166:167], v[166:167], s[46:47] op_sel_hi:[1,1,0]
    v_pk_mul_f32 v[48:49], v[48:49], v[160:161] neg_lo:[1,0] neg_hi:[1,0]
    v_pk_mul_f32 v[50:51], v[50:51], v[162:163] neg_lo:[1,0] neg_hi:[1,0]
    v_pk_mul_f32 v[52:53], v[52:53], v[164:165] neg_lo:[1,0] neg_hi:[1,0]
    v_pk_mul_f32 v[54:55], v[54:55], v[166:167] neg_lo:[1,0] neg_hi:[1,0]
    v_exp_f32 v48, v48
    v_exp_f32 v49, v49
    v_exp_f32 v50, v50
    v_exp_f32 v51, v51
    v_exp_f32 v52, v52
    v_exp_f32 v53, v53
    v_exp_f32 v54, v54
    v_exp_f32 v55, v55
    v_pk_fma_f32 v[48:49], v[48:49], s[46:47], s[46:47] op_sel:[0,1,1] op_sel_hi:[1,1,1]
    v_pk_fma_f32 v[50:51], v[50:51], s[46:47], s[46:47] op_sel:[0,1,1] op_sel_hi:[1,1,1]
    v_pk_fma_f32 v[52:53], v[52:53], s[46:47], s[46:47] op_sel:[0,1,1] op_sel_hi:[1,1,1]
    v_pk_fma_f32 v[54:55], v[54:55], s[46:47], s[46:47] op_sel:[0,1,1] op_sel_hi:[1,1,1]
    v_rcp_f32 v48, v48
    v_rcp_f32 v49, v49
    v_rcp_f32 v50, v50
    v_rcp_f32 v51, v51
    v_rcp_f32 v52, v52
    v_rcp_f32 v53, v53
    v_rcp_f32 v54, v54
    v_rcp_f32 v55, v55
    v_pk_mul_f32 v[48:49], v[48:49], v[160:161]
    v_pk_mul_f32 v[50:51], v[50:51], v[162:163]
    v_pk_mul_f32 v[52:53], v[52:53], v[164:165]
    v_pk_mul_f32 v[54:55], v[54:55], v[166:167]
    v_cvt_pk_bf16_f32 v72, v48, v49
    v_cvt_pk_bf16_f32 v73, v50, v51
    v_cvt_pk_bf16_f32 v74, v52, v53
    v_cvt_pk_bf16_f32 v75, v54, v55
    buffer_store_dwordx4 v[72:75], v1, s[28:31], 0 offen offset:2048 sc1
    v_pk_fma_f32 v[176:177], v[176:177], v[96:97], v[100:101]
    v_pk_fma_f32 v[178:179], v[178:179], v[98:99], v[102:103]
    v_pk_fma_f32 v[180:181], v[180:181], v[104:105], v[108:109]
    v_pk_fma_f32 v[182:183], v[182:183], v[106:107], v[110:111]
    v_pk_fma_f32 v[56:57], v[176:177], v[176:177], s[46:47] op_sel_hi:[1,1,0]
    v_pk_fma_f32 v[58:59], v[178:179], v[178:179], s[46:47] op_sel_hi:[1,1,0]
    v_pk_fma_f32 v[60:61], v[180:181], v[180:181], s[46:47] op_sel_hi:[1,1,0]
    v_pk_fma_f32 v[62:63], v[182:183], v[182:183], s[46:47] op_sel_hi:[1,1,0]
    v_pk_mul_f32 v[56:57], v[56:57], v[176:177] neg_lo:[1,0] neg_hi:[1,0]
    v_pk_mul_f32 v[58:59], v[58:59], v[178:179] neg_lo:[1,0] neg_hi:[1,0]
    v_pk_mul_f32 v[60:61], v[60:61], v[180:181] neg_lo:[1,0] neg_hi:[1,0]
    v_pk_mul_f32 v[62:63], v[62:63], v[182:183] neg_lo:[1,0] neg_hi:[1,0]
    v_exp_f32 v56, v56
    v_exp_f32 v57, v57
    v_exp_f32 v58, v58
    v_exp_f32 v59, v59
    v_exp_f32 v60, v60
    v_exp_f32 v61, v61
    v_exp_f32 v62, v62
    v_exp_f32 v63, v63
    v_pk_fma_f32 v[56:57], v[56:57], s[46:47], s[46:47] op_sel:[0,1,1] op_sel_hi:[1,1,1]
    v_pk_fma_f32 v[58:59], v[58:59], s[46:47], s[46:47] op_sel:[0,1,1] op_sel_hi:[1,1,1]
    v_pk_fma_f32 v[60:61], v[60:61], s[46:47], s[46:47] op_sel:[0,1,1] op_sel_hi:[1,1,1]
    v_pk_fma_f32 v[62:63], v[62:63], s[46:47], s[46:47] op_sel:[0,1,1] op_sel_hi:[1,1,1]
    v_rcp_f32 v56, v56
    v_rcp_f32 v57, v57
    v_rcp_f32 v58, v58
    v_rcp_f32 v59, v59
    v_rcp_f32 v60, v60
    v_rcp_f32 v61, v61
    v_rcp_f32 v62, v62
    v_rcp_f32 v63, v63
    v_pk_mul_f32 v[56:57], v[56:57], v[176:177]
    v_pk_mul_f32 v[58:59], v[58:59], v[178:179]
    v_pk_mul_f32 v[60:61], v[60:61], v[180:181]
    v_pk_mul_f32 v[62:63], v[62:63], v[182:183]
    v_cvt_pk_bf16_f32 v76, v56, v57
    v_cvt_pk_bf16_f32 v77, v58, v59
    v_cvt_pk_bf16_f32 v78, v60, v61
    v_cvt_pk_bf16_f32 v79, v62, v63
    buffer_store_dwordx4 v[76:79], v1, s[28:31], 0 offen offset:3072 sc1
    v_pk_fma_f32 v[192:193], v[192:193], v[96:97], v[100:101]
    v_pk_fma_f32 v[194:195], v[194:195], v[98:99], v[102:103]
    v_pk_fma_f32 v[196:197], v[196:197], v[104:105], v[108:109]
    v_pk_fma_f32 v[198:199], v[198:199], v[106:107], v[110:111]
    v_pk_fma_f32 v[32:33], v[192:193], v[192:193], s[46:47] op_sel_hi:[1,1,0]
    v_pk_fma_f32 v[34:35], v[194:195], v[194:195], s[46:47] op_sel_hi:[1,1,0]
    v_pk_fma_f32 v[36:37], v[196:197], v[196:197], s[46:47] op_sel_hi:[1,1,0]
    v_pk_fma_f32 v[38:39], v[198:199], v[198:199], s[46:47] op_sel_hi:[1,1,0]
    v_pk_mul_f32 v[32:33], v[32:33], v[192:193] neg_lo:[1,0] neg_hi:[1,0]
    v_pk_mul_f32 v[34:35], v[34:35], v[194:195] neg_lo:[1,0] neg_hi:[1,0]
    v_pk_mul_f32 v[36:37], v[36:37], v[196:197] neg_lo:[1,0] neg_hi:[1,0]
    v_pk_mul_f32 v[38:39], v[38:39], v[198:199] neg_lo:[1,0] neg_hi:[1,0]
    v_exp_f32 v32, v32
    v_exp_f32 v33, v33
    v_exp_f32 v34, v34
    v_exp_f32 v35, v35
    v_exp_f32 v36, v36
    v_exp_f32 v37, v37
    v_exp_f32 v38, v38
    v_exp_f32 v39, v39
    v_pk_fma_f32 v[32:33], v[32:33], s[46:47], s[46:47] op_sel:[0,1,1] op_sel_hi:[1,1,1]
    v_pk_fma_f32 v[34:35], v[34:35], s[46:47], s[46:47] op_sel:[0,1,1] op_sel_hi:[1,1,1]
    v_pk_fma_f32 v[36:37], v[36:37], s[46:47], s[46:47] op_sel:[0,1,1] op_sel_hi:[1,1,1]
    v_pk_fma_f32 v[38:39], v[38:39], s[46:47], s[46:47] op_sel:[0,1,1] op_sel_hi:[1,1,1]
    v_rcp_f32 v32, v32
    v_rcp_f32 v33, v33
    v_rcp_f32 v34, v34
    v_rcp_f32 v35, v35
    v_rcp_f32 v36, v36
    v_rcp_f32 v37, v37
    v_rcp_f32 v38, v38
    v_rcp_f32 v39, v39
    v_pk_mul_f32 v[32:33], v[32:33], v[192:193]
    v_pk_mul_f32 v[34:35], v[34:35], v[194:195]
    v_pk_mul_f32 v[36:37], v[36:37], v[196:197]
    v_pk_mul_f32 v[38:39], v[38:39], v[198:199]
    v_cvt_pk_bf16_f32 v80, v32, v33
    v_cvt_pk_bf16_f32 v81, v34, v35
    v_cvt_pk_bf16_f32 v82, v36, v37
    v_cvt_pk_bf16_f32 v83, v38, v39
    buffer_store_dwordx4 v[80:83], v1, s[28:31], s64 offen offset:0 sc1
    v_pk_fma_f32 v[208:209], v[208:209], v[96:97], v[100:101]
    v_pk_fma_f32 v[210:211], v[210:211], v[98:99], v[102:103]
    v_pk_fma_f32 v[212:213], v[212:213], v[104:105], v[108:109]
    v_pk_fma_f32 v[214:215], v[214:215], v[106:107], v[110:111]
    v_pk_fma_f32 v[40:41], v[208:209], v[208:209], s[46:47] op_sel_hi:[1,1,0]
    v_pk_fma_f32 v[42:43], v[210:211], v[210:211], s[46:47] op_sel_hi:[1,1,0]
    v_pk_fma_f32 v[44:45], v[212:213], v[212:213], s[46:47] op_sel_hi:[1,1,0]
    v_pk_fma_f32 v[46:47], v[214:215], v[214:215], s[46:47] op_sel_hi:[1,1,0]
    v_pk_mul_f32 v[40:41], v[40:41], v[208:209] neg_lo:[1,0] neg_hi:[1,0]
    v_pk_mul_f32 v[42:43], v[42:43], v[210:211] neg_lo:[1,0] neg_hi:[1,0]
    v_pk_mul_f32 v[44:45], v[44:45], v[212:213] neg_lo:[1,0] neg_hi:[1,0]
    v_pk_mul_f32 v[46:47], v[46:47], v[214:215] neg_lo:[1,0] neg_hi:[1,0]
    v_exp_f32 v40, v40
    v_exp_f32 v41, v41
    v_exp_f32 v42, v42
    v_exp_f32 v43, v43
    v_exp_f32 v44, v44
    v_exp_f32 v45, v45
    v_exp_f32 v46, v46
    v_exp_f32 v47, v47
    v_pk_fma_f32 v[40:41], v[40:41], s[46:47], s[46:47] op_sel:[0,1,1] op_sel_hi:[1,1,1]
    v_pk_fma_f32 v[42:43], v[42:43], s[46:47], s[46:47] op_sel:[0,1,1] op_sel_hi:[1,1,1]
    v_pk_fma_f32 v[44:45], v[44:45], s[46:47], s[46:47] op_sel:[0,1,1] op_sel_hi:[1,1,1]
    v_pk_fma_f32 v[46:47], v[46:47], s[46:47], s[46:47] op_sel:[0,1,1] op_sel_hi:[1,1,1]
    v_rcp_f32 v40, v40
    v_rcp_f32 v41, v41
    v_rcp_f32 v42, v42
    v_rcp_f32 v43, v43
    v_rcp_f32 v44, v44
    v_rcp_f32 v45, v45
    v_rcp_f32 v46, v46
    v_rcp_f32 v47, v47
    v_pk_mul_f32 v[40:41], v[40:41], v[208:209]
    v_pk_mul_f32 v[42:43], v[42:43], v[210:211]
    v_pk_mul_f32 v[44:45], v[44:45], v[212:213]
    v_pk_mul_f32 v[46:47], v[46:47], v[214:215]
    v_cvt_pk_bf16_f32 v84, v40, v41
    v_cvt_pk_bf16_f32 v85, v42, v43
    v_cvt_pk_bf16_f32 v86, v44, v45
    v_cvt_pk_bf16_f32 v87, v46, v47
    buffer_store_dwordx4 v[84:87], v1, s[28:31], s64 offen offset:1024 sc1
    v_pk_fma_f32 v[224:225], v[224:225], v[96:97], v[100:101]
    v_pk_fma_f32 v[226:227], v[226:227], v[98:99], v[102:103]
    v_pk_fma_f32 v[228:229], v[228:229], v[104:105], v[108:109]
    v_pk_fma_f32 v[230:231], v[230:231], v[106:107], v[110:111]
    v_pk_fma_f32 v[48:49], v[224:225], v[224:225], s[46:47] op_sel_hi:[1,1,0]
    v_pk_fma_f32 v[50:51], v[226:227], v[226:227], s[46:47] op_sel_hi:[1,1,0]
    v_pk_fma_f32 v[52:53], v[228:229], v[228:229], s[46:47] op_sel_hi:[1,1,0]
    v_pk_fma_f32 v[54:55], v[230:231], v[230:231], s[46:47] op_sel_hi:[1,1,0]
    v_pk_mul_f32 v[48:49], v[48:49], v[224:225] neg_lo:[1,0] neg_hi:[1,0]
    v_pk_mul_f32 v[50:51], v[50:51], v[226:227] neg_lo:[1,0] neg_hi:[1,0]
    v_pk_mul_f32 v[52:53], v[52:53], v[228:229] neg_lo:[1,0] neg_hi:[1,0]
    v_pk_mul_f32 v[54:55], v[54:55], v[230:231] neg_lo:[1,0] neg_hi:[1,0]
    v_exp_f32 v48, v48
    v_exp_f32 v49, v49
    v_exp_f32 v50, v50
    v_exp_f32 v51, v51
    v_exp_f32 v52, v52
    v_exp_f32 v53, v53
    v_exp_f32 v54, v54
    v_exp_f32 v55, v55
    v_pk_fma_f32 v[48:49], v[48:49], s[46:47], s[46:47] op_sel:[0,1,1] op_sel_hi:[1,1,1]
    v_pk_fma_f32 v[50:51], v[50:51], s[46:47], s[46:47] op_sel:[0,1,1] op_sel_hi:[1,1,1]
    v_pk_fma_f32 v[52:53], v[52:53], s[46:47], s[46:47] op_sel:[0,1,1] op_sel_hi:[1,1,1]
    v_pk_fma_f32 v[54:55], v[54:55], s[46:47], s[46:47] op_sel:[0,1,1] op_sel_hi:[1,1,1]
    v_rcp_f32 v48, v48
    v_rcp_f32 v49, v49
    v_rcp_f32 v50, v50
    v_rcp_f32 v51, v51
    v_rcp_f32 v52, v52
    v_rcp_f32 v53, v53
    v_rcp_f32 v54, v54
    v_rcp_f32 v55, v55
    v_pk_mul_f32 v[48:49], v[48:49], v[224:225]
    v_pk_mul_f32 v[50:51], v[50:51], v[226:227]
    v_pk_mul_f32 v[52:53], v[52:53], v[228:229]
    v_pk_mul_f32 v[54:55], v[54:55], v[230:231]
    v_cvt_pk_bf16_f32 v88, v48, v49
    v_cvt_pk_bf16_f32 v89, v50, v51
    v_cvt_pk_bf16_f32 v90, v52, v53
    v_cvt_pk_bf16_f32 v91, v54, v55
    buffer_store_dwordx4 v[88:91], v1, s[28:31], s64 offen offset:2048 sc1
    v_pk_fma_f32 v[240:241], v[240:241], v[96:97], v[100:101]
    v_pk_fma_f32 v[242:243], v[242:243], v[98:99], v[102:103]
    v_pk_fma_f32 v[244:245], v[244:245], v[104:105], v[108:109]
    v_pk_fma_f32 v[246:247], v[246:247], v[106:107], v[110:111]
    v_pk_fma_f32 v[56:57], v[240:241], v[240:241], s[46:47] op_sel_hi:[1,1,0]
    v_pk_fma_f32 v[58:59], v[242:243], v[242:243], s[46:47] op_sel_hi:[1,1,0]
    v_pk_fma_f32 v[60:61], v[244:245], v[244:245], s[46:47] op_sel_hi:[1,1,0]
    v_pk_fma_f32 v[62:63], v[246:247], v[246:247], s[46:47] op_sel_hi:[1,1,0]
    v_pk_mul_f32 v[56:57], v[56:57], v[240:241] neg_lo:[1,0] neg_hi:[1,0]
    v_pk_mul_f32 v[58:59], v[58:59], v[242:243] neg_lo:[1,0] neg_hi:[1,0]
    v_pk_mul_f32 v[60:61], v[60:61], v[244:245] neg_lo:[1,0] neg_hi:[1,0]
    v_pk_mul_f32 v[62:63], v[62:63], v[246:247] neg_lo:[1,0] neg_hi:[1,0]
    v_exp_f32 v56, v56
    v_exp_f32 v57, v57
    v_exp_f32 v58, v58
    v_exp_f32 v59, v59
    v_exp_f32 v60, v60
    v_exp_f32 v61, v61
    v_exp_f32 v62, v62
    v_exp_f32 v63, v63
    v_pk_fma_f32 v[56:57], v[56:57], s[46:47], s[46:47] op_sel:[0,1,1] op_sel_hi:[1,1,1]
    v_pk_fma_f32 v[58:59], v[58:59], s[46:47], s[46:47] op_sel:[0,1,1] op_sel_hi:[1,1,1]
    v_pk_fma_f32 v[60:61], v[60:61], s[46:47], s[46:47] op_sel:[0,1,1] op_sel_hi:[1,1,1]
    v_pk_fma_f32 v[62:63], v[62:63], s[46:47], s[46:47] op_sel:[0,1,1] op_sel_hi:[1,1,1]
    v_rcp_f32 v56, v56
    v_rcp_f32 v57, v57
    v_rcp_f32 v58, v58
    v_rcp_f32 v59, v59
    v_rcp_f32 v60, v60
    v_rcp_f32 v61, v61
    v_rcp_f32 v62, v62
    v_rcp_f32 v63, v63
    v_pk_mul_f32 v[56:57], v[56:57], v[240:241]
    v_pk_mul_f32 v[58:59], v[58:59], v[242:243]
    v_pk_mul_f32 v[60:61], v[60:61], v[244:245]
    v_pk_mul_f32 v[62:63], v[62:63], v[246:247]
    v_cvt_pk_bf16_f32 v92, v56, v57
    v_cvt_pk_bf16_f32 v93, v58, v59
    v_cvt_pk_bf16_f32 v94, v60, v61
    v_cvt_pk_bf16_f32 v95, v62, v63
    buffer_store_dwordx4 v[92:95], v1, s[28:31], s64 offen offset:3072 sc1
    s_cbranch_scc0 L_epi2
L_epi_done:
L_end:
    s_endpgm
L_cpe:
    s_getpc_b64 s[72:73]
L_pce:
    s_sub_u32 s72, s72, L_pce-standalone__self_sup_conv_stem_wavlm__speech_kernel
    s_subb_u32 s73, s73, 0
    s_lshl_b32 s52, s54, 6
    v_add_lshl_u32 v48, s52, v0, 7
    v_min_u32 v48, L_code_end-standalone__self_sup_conv_stem_wavlm__speech_kernel-4, v48
    v_mov_b32 v49, s73
    v_add_co_u32 v48, vcc, s72, v48
    s_nop 1
    v_addc_co_u32 v49, vcc, 0, v49, vcc
    global_load_dword v50, v[48:49], off
    s_branch L_cpe_back
L_ld_out:
    s_waitcnt vmcnt(12)
    s_barrier
    s_mov_b32 s40, s8
    s_mov_b32 s41, s9
    s_mov_b32 s42, 1024
    s_mov_b32 s43, 0x00020000
    s_mov_b32 s44, s10
    s_mov_b32 s45, s11
    s_mov_b32 s46, 1024
    s_mov_b32 s47, 0x00020000
    s_mov_b32 s36, s14
    s_mov_b32 s37, s15
    s_mov_b32 s38, 256
    s_mov_b32 s39, 0x00020000
    s_lshl_b32 s52, s63, 16
    s_add_u32 s32, s16, s52
    s_addc_u32 s33, s17, 0
    s_mov_b32 s34, 65536
    s_mov_b32 s35, 0x00020000
    v_and_b32 v6, 3, v0
    v_lshrrev_b32 v7, 5, v0
    v_lshl_add_u32 v6, v6, 2, v7
    v_bfe_u32 v7, v0, 4, 1
    v_lshl_add_u32 v6, v7, 1, v6
    s_lshl_b32 s53, s48, 7
    s_lshr_b32 s52, s54, 1
    s_lshl_b32 s52, s52, 6
    s_add_u32 s53, s52, s53
    s_and_b32 s52, s54, 1
    s_lshl_b32 s52, s52, 2
    s_add_u32 s53, s52, s53
    v_and_b32 v7, 12, v6
    v_add_u32 v7, v7, v6
    v_add_lshl_u32 v7, s53, v7, 1
    buffer_load_ushort v40, v7, s[40:43], 0 offen
    buffer_load_ushort v41, v7, s[44:47], 0 offen
    buffer_load_ushort v42, v7, s[40:43], 64 offen
    buffer_load_ushort v43, v7, s[44:47], 64 offen
    v_mov_b32 v24, 0
    s_lshl_b32 s53, s63, 5
    buffer_load_dword v25, v24, s[36:39], s53 offen sc1
    s_and_b32 s52, s54, 1
    s_lshl_b32 s52, s52, 4
    v_add_lshl_u32 v20, s52, v6, 2
    s_lshr_b32 s52, s54, 1
    s_lshl_b32 s52, s52, 11
    s_add_u32 s52, s52, 92032
    v_add_u32 v20, s52, v20
    v_lshrrev_b32 v2, 3, v0
    v_lshlrev_b32 v2, 9, v2
    v_and_b32 v3, 7, v0
    v_lshl_add_u32 v2, v3, 4, v2
    s_lshl_b32 s52, s54, 7
    v_add_u32 v22, s52, v2
    s_waitcnt lgkmcnt(0)
    s_mov_b32 s64, 0
    s_mov_b32 s65, 4096
    s_mov_b32 s66, 8192
    s_mov_b32 s67, 12288
    s_mov_b32 s68, 16384
    s_mov_b32 s69, 20480
    s_mov_b32 s70, 24576
    s_mov_b32 s71, 28672
    s_mov_b32 s72, 0x0f0f0f0f
    s_mov_b32 s73, 0x0f0f0f0f
    s_mov_b32 s74, 0
    s_waitcnt vmcnt(5)
    s_barrier
    s_branch L_clr_chk
L_clr_poll:
    buffer_load_dword v25, v24, s[36:39], s53 offen sc1
L_clr_chk:
    s_waitcnt vmcnt(0)
    v_readfirstlane_b32 s52, v25
    s_add_u32 s74, s74, 1
    s_cmp_ge_u32 s74, 131072
    s_cbranch_scc1 L_clr_done
    s_cmp_lt_u32 s52, 32
    s_cbranch_scc1 L_clr_poll
L_clr_done:
    v_lshlrev_b32 v8, 16, v40
    v_lshlrev_b32 v9, 16, v41
    v_lshlrev_b32 v10, 16, v42
    v_lshlrev_b32 v11, 16, v43
    v_mul_f32 v8, 0x3eeff558, v8
    v_mul_f32 v9, 0x3eeff558, v9
    v_mul_f32 v10, 0x3eeff558, v10
    v_mul_f32 v11, 0x3eeff558, v11
    s_setprio 3
    s_mov_b32 s74, 0
L_half:
    s_barrier
    buffer_load_dwordx4 v[32:35], v22, s[32:35], s64 offen sc1
    buffer_load_dwordx4 v[36:39], v22, s[32:35], s65 offen sc1
    buffer_load_dwordx4 v[40:43], v22, s[32:35], s66 offen sc1
    buffer_load_dwordx4 v[44:47], v22, s[32:35], s67 offen sc1
    buffer_load_dwordx4 v[48:51], v22, s[32:35], s68 offen sc1
    buffer_load_dwordx4 v[52:55], v22, s[32:35], s69 offen sc1
    buffer_load_dwordx4 v[56:59], v22, s[32:35], s70 offen sc1
    buffer_load_dwordx4 v[60:63], v22, s[32:35], s71 offen sc1
L_chk:
    s_waitcnt vmcnt(6)
    v_pk_add_f32 v[96:97], v[32:33], v[36:37]
    v_pk_add_f32 v[98:99], v[34:35], v[38:39]
    s_waitcnt vmcnt(4)
    v_pk_add_f32 v[100:101], v[40:41], v[44:45]
    v_pk_add_f32 v[102:103], v[42:43], v[46:47]
    v_pk_add_f32 v[96:97], v[96:97], v[100:101]
    v_pk_add_f32 v[98:99], v[98:99], v[102:103]
    s_waitcnt vmcnt(2)
    v_pk_add_f32 v[104:105], v[48:49], v[52:53]
    v_pk_add_f32 v[106:107], v[50:51], v[54:55]
    v_pk_add_f32 v[96:97], v[96:97], v[104:105]
    v_pk_add_f32 v[98:99], v[98:99], v[106:107]
    s_waitcnt vmcnt(0)
    v_pk_add_f32 v[108:109], v[56:57], v[60:61]
    v_pk_add_f32 v[110:111], v[58:59], v[62:63]
    v_pk_add_f32 v[96:97], v[96:97], v[108:109]
    v_pk_add_f32 v[98:99], v[98:99], v[110:111]
    s_nop 0
    v_permlane32_swap_b32 v96, v97
    v_permlane32_swap_b32 v98, v99
    v_add_f32 v96, v96, v97
    v_add_f32 v98, v98, v99
    s_nop 1
    v_permlane16_swap_b32 v96, v98
    v_add_f32 v96, v96, v98
    v_cmp_u_f32 s[30:31], v96, v96
    s_nop 0
    v_add_f32_dpp v96, v96, v96 row_ror:8 row_mask:0xf bank_mask:0xf
    s_cmp_eq_u64 s[30:31], 0
    s_cbranch_scc1 L_done
    v_max3_u32 v112, v32, v33, v34
    v_max_u32 v112, v112, v35
    v_cmp_eq_u32 s[4:5], -1, v112
    v_max3_u32 v113, v36, v37, v38
    v_max_u32 v113, v113, v39
    v_cmp_eq_u32 s[6:7], -1, v113
    v_max3_u32 v114, v40, v41, v42
    v_max_u32 v114, v114, v43
    v_cmp_eq_u32 s[8:9], -1, v114
    s_or_b64 s[30:31], s[4:5], s[6:7]
    v_max3_u32 v115, v44, v45, v46
    v_max_u32 v115, v115, v47
    v_cmp_eq_u32 s[10:11], -1, v115
    s_or_b64 s[30:31], s[30:31], s[8:9]
    v_max3_u32 v116, v48, v49, v50
    v_max_u32 v116, v116, v51
    v_cmp_eq_u32 s[12:13], -1, v116
    s_or_b64 s[30:31], s[30:31], s[10:11]
    v_max3_u32 v117, v52, v53, v54
    v_max_u32 v117, v117, v55
    v_cmp_eq_u32 s[14:15], -1, v117
    s_or_b64 s[30:31], s[30:31], s[12:13]
    v_max3_u32 v118, v56, v57, v58
    v_max_u32 v118, v118, v59
    v_cmp_eq_u32 s[18:19], -1, v118
    s_or_b64 s[30:31], s[30:31], s[14:15]
    v_max3_u32 v119, v60, v61, v62
    v_max_u32 v119, v119, v63
    v_cmp_eq_u32 s[28:29], -1, v119
    s_or_b64 s[30:31], s[30:31], s[18:19]
    s_or_b64 s[30:31], s[30:31], s[28:29]
    s_cbranch_scc0 L_done
    s_add_u32 s74, s74, 1
    s_cmp_ge_u32 s74, 131072
    s_cbranch_scc1 L_done
    s_mov_b64 exec, s[4:5]
    buffer_load_dwordx4 v[32:35], v22, s[32:35], s64 offen sc1
    s_mov_b64 exec, s[6:7]
    buffer_load_dwordx4 v[36:39], v22, s[32:35], s65 offen sc1
    s_mov_b64 exec, s[8:9]
    buffer_load_dwordx4 v[40:43], v22, s[32:35], s66 offen sc1
    s_mov_b64 exec, s[10:11]
    buffer_load_dwordx4 v[44:47], v22, s[32:35], s67 offen sc1
    s_mov_b64 exec, s[12:13]
    buffer_load_dwordx4 v[48:51], v22, s[32:35], s68 offen sc1
    s_mov_b64 exec, s[14:15]
    buffer_load_dwordx4 v[52:55], v22, s[32:35], s69 offen sc1
    s_mov_b64 exec, s[18:19]
    buffer_load_dwordx4 v[56:59], v22, s[32:35], s70 offen sc1
    s_mov_b64 exec, s[28:29]
    buffer_load_dwordx4 v[60:63], v22, s[32:35], s71 offen sc1
    s_mov_b64 exec, -1
    s_waitcnt vmcnt(0)
    s_branch L_chk
L_done:
    v_mul_f32 v96, 0x390316a0, v96
    s_nop 1
    v_mov_b32_dpp v97, v96 row_ror:4 row_mask:0xf bank_mask:0xf
    v_fma_f32 v97, -v96, v96, v97
    v_max_f32 v97, 0, v97
    v_add_f32 v97, 0x3727c5ac, v97
    v_rsq_f32 v97, v97
    s_mov_b64 exec, s[72:73]
    v_mul_f32 v98, v8, v97
    v_fma_f32 v99, -v96, v98, v9
    ds_write2st64_b32 v20, v98, v99 offset0:0 offset1:16
    s_mov_b64 exec, -1
    s_cmp_lg_u32 s57, 0
    s_waitcnt lgkmcnt(0)
    s_barrier
    s_cbranch_scc1 L_ld_end
    v_mov_b32 v8, v10
    v_mov_b32 v9, v11
    v_add_u32 v20, 32768, v20
    v_add_u32 v22, 32768, v22
    s_mov_b32 s57, 1
    s_branch L_half
L_ld_end:
    s_endpgm
L_code_end:
.section .rodata,"a"
.p2align 6
.amdhsa_kernel standalone__self_sup_conv_stem_wavlm__speech_kernel
  .amdhsa_next_free_vgpr 256
  .amdhsa_next_free_sgpr 102
  .amdhsa_accum_offset 256
  .amdhsa_group_segment_fixed_size 0
  .amdhsa_kernarg_size 56
  .amdhsa_user_sgpr_count 2
  .amdhsa_user_sgpr_kernarg_segment_ptr 1
  .amdhsa_system_sgpr_workgroup_id_x 1
  .amdhsa_float_denorm_mode_32 3
.end_amdhsa_kernel
```
